```python
import torch

def _softmax(x, axis=-1):
    return torch.softmax(x, dim=axis)
def _gelu(x):
    return torch.nn.functional.gelu(x, approximate="tanh")
def _silu(x):
    return torch.nn.functional.silu(x)
def _sigmoid(x):
    return torch.sigmoid(x)
def _layernorm(x, axis=-1, eps=1e-5):
    m = x.mean(dim=axis, keepdim=True)
    v = x.var(dim=axis, keepdim=True, unbiased=False)
    return (x - m) / torch.sqrt(v + eps)
def _scatter_add(tgt, idx, src, axis=0):
    return tgt.clone().index_add_(axis, idx, src)
def _segment_sum(src, seg, n):
    out = torch.zeros((n,) + src.shape[1:], dtype=src.dtype)
    return out.index_add_(0, seg, src)
def _pad(x, pw):
    flat = tuple(v for pair in reversed(pw) for v in pair)
    return torch.nn.functional.pad(x, flat)

kernel_name = 'gated_mix__ssm_conv_s4d__moe_arch_mod__prompt'

def setup_inputs():

    _w = (lambda a: (lambda t: t.to(torch.bfloat16) if t.is_floating_point() else t)(torch.as_tensor(a)))
    def _A_setup():
        Bsz, L, D, N = 1, 2048, 512, 128
        return {
            "u": _w((lambda *s: torch.randn(*s, dtype=torch.bfloat16) * 0.05)(Bsz, L, D)),
            "log_A_real": _w((lambda *s: torch.randn(*s, dtype=torch.bfloat16) * 3.2)(D, N) * 0.5),
            "A_imag": _w((lambda *s: torch.randn(*s, dtype=torch.bfloat16) * 0.1)(D, N) * 3.14),
            "C_real": _w((lambda *s: torch.randn(*s, dtype=torch.bfloat16) * 1.6)(D, N) / N ** 0.5),
            "C_imag": _w((lambda *s: torch.randn(*s, dtype=torch.bfloat16) * 1.6)(D, N) / N ** 0.5),
            "log_dt": _w((lambda *s: torch.randn(*s, dtype=torch.bfloat16) * 0.1)(D) * 0.5 - 4.0),
            "D_skip": _w((lambda *s: torch.randn(*s, dtype=torch.bfloat16) * 0.2)(D)),
        }
    _A_in = _A_setup()

    def _B_setup():
        B, S, D, F, C = 1, 2048, 512, 1792, 1
        return {
            "x": _w((lambda *s: torch.randn(*s, dtype=torch.bfloat16) * 0.05)(B, S, D)),
            "w_r": _w((lambda *s: torch.randn(*s, dtype=torch.bfloat16) * 3.2)(D)),
            "w_gate": _w((lambda *s: torch.randn(*s, dtype=torch.bfloat16) * 0.2)(D, F)),
            "w_up": _w((lambda *s: torch.randn(*s, dtype=torch.bfloat16) * 0.2)(D, F)),
            "w_down": _w((lambda *s: torch.randn(*s, dtype=torch.bfloat16) * 0.2)(F, D)),
        }
    _B_in = _B_setup()

    return {
        "A_u": _A_in["u"],
        "A_log_A_real": _A_in["log_A_real"],
        "A_A_imag": _A_in["A_imag"],
        "A_C_real": _A_in["C_real"],
        "A_C_imag": _A_in["C_imag"],
        "A_log_dt": _A_in["log_dt"],
        "A_D_skip": _A_in["D_skip"],
        "B_x": _B_in["x"],
        "B_w_r": _B_in["w_r"],
        "B_w_gate": _B_in["w_gate"],
        "B_w_up": _B_in["w_up"],
        "B_w_down": _B_in["w_down"],
        "gate_w": _w((lambda *s: torch.randn(*s, dtype=torch.bfloat16) * 0.05)(512) * 16.0),
    }

def reference(A_u, A_log_A_real, A_A_imag, A_C_real, A_C_imag, A_log_dt, A_D_skip, B_x, B_w_r, B_w_gate, B_w_up, B_w_down, gate_w):
    def _A_ref(u, log_A_real, A_imag, C_real, C_imag, log_dt, D_skip):
        L = u.shape[1]
        dt = torch.exp(log_dt)
        A = -torch.exp(log_A_real) + 1j * A_imag
        C = (C_real + 1j * C_imag) * dt[:, None]
        pos = (lambda x, dt: x.to(dt))(torch.arange(L), log_dt.dtype)
        P = torch.exp((A * dt[:, None])[:, :, None] * pos[None, None, :])
        K = 2.0 * torch.einsum("dn,dnl->dl", C, P).real
        L2 = 2 * L
        u_t = (lambda x, *d: x.permute(*d))(u, 0, 2, 1)
        Kf = (lambda x, *a, **k: torch.fft.rfft(x.float(), *a, **k))(K, L2)
        Uf = (lambda x, *a, **k: torch.fft.rfft(x.float(), *a, **k))(u_t, L2)
        y = (lambda x, *a, **k: torch.fft.irfft(x, *a, **k).to(torch.bfloat16))(Uf * Kf[None, :, :], L2)[:, :, :L]
        y = (lambda x, *d: x.permute(*d))(y, 0, 2, 1)
        return y + u * D_skip[None, None, :]

    def _B_ref(x, w_r, w_gate, w_up, w_down):
        B, S, D = x.shape
        C = 1
        r = x @ w_r
        idx = torch.argsort(-r, axis=-1)[:, :C]
        idx_e = (lambda x, n, axis: torch.repeat_interleave(x, n, dim=axis))(idx.reshape(B, C, 1), D, axis=2)
        x_sel = (lambda x, i, axis: torch.take_along_dim(x, i, dim=axis))(x, idx_e, axis=1)
        g = _silu(x_sel @ w_gate)
        u = x_sel @ w_up
        y = (g * u) @ w_down
        r_sel = _sigmoid((lambda x, i, axis: torch.take_along_dim(x, i, dim=axis))(r, idx, axis=1))
        y = y * r_sel.reshape(B, C, 1)
        b_off = (torch.arange(B) * S).reshape(B, 1)
        flat_idx = (idx + b_off).reshape(B * C)
        zero = (x * 0.0).reshape(B * S, D)
        upd = _scatter_add(zero, flat_idx, y.reshape(B * C, D), axis=0)
        return x + upd.reshape(B, S, D)

    x = A_u
    g = _sigmoid((x * gate_w).sum(-1, keepdims=True))
    a = _A_ref(x, A_log_A_real, A_A_imag, A_C_real, A_C_imag, A_log_dt, A_D_skip)
    b = _B_ref(x, B_w_r, B_w_gate, B_w_up, B_w_down)
    return g * a + (1 - g) * b
```

```asm
; @launch grid=(256,1,1) block=(512,1,1) lds=148624
.amdgcn_target "amdgcn-amd-amdhsa--gfx950"
.text
.globl gated_mix__ssm_conv_s4d__moe_arch_mod__prompt_kernel
.p2align 12
.rept 832
    s_endpgm
.endr
.p2align 8
.type gated_mix__ssm_conv_s4d__moe_arch_mod__prompt_kernel,@function
gated_mix__ssm_conv_s4d__moe_arch_mod__prompt_kernel:
    s_load_dwordx16 s[8:23], s[0:1], 0
    s_load_dwordx16 s[24:39], s[0:1], 64
    s_getpc_b64 s[4:5]
L_pc:
    v_lshlrev_b32 v1, 7, v0
    v_min_u32 v1, L_code_end-L_pc-4, v1
    global_load_dword v2, v1, s[4:5]
    v_readfirstlane_b32 s40, v0
    s_and_b32 s41, s2, 7
    s_lshr_b32 s42, s2, 3
    v_and_b32 v9, 63, v0
    s_lshr_b32 s40, s40, 6
    s_cmp_ge_u32 s42, 16
    s_cbranch_scc1 L_convh
    s_cmp_ge_u32 s42, 8
    s_cbranch_scc1 L_ffnh
    s_lshl3_add_u32 s43, s41, s42
    v_lshlrev_b32 v3, 4, v9
    s_lshl3_add_u32 s45, s43, s40
    s_lshl_b32 s44, s45, 12
    v_add_u32 v4, s44, v3
    s_add_u32 s44, s43, 16
    s_lshl_b32 s44, s44, 11
    v_lshl_add_u32 v5, v0, 2, s44
    v_mov_b32 v6, 0
    s_waitcnt lgkmcnt(0)
    global_store_dword v5, v6, s[38:39] sc1
    global_load_dwordx4 v[32:35], v3, s[24:25]
    global_load_dwordx4 v[36:39], v3, s[32:33]
    global_load_dwordx4 v[16:19], v4, s[8:9] offset:0
    global_load_dwordx4 v[20:23], v4, s[8:9] offset:1024
    global_load_dwordx4 v[24:27], v4, s[8:9] offset:2048
    global_load_dwordx4 v[28:31], v4, s[8:9] offset:3072
    s_branch L_router2
L_convh:
    s_sub_u32 s42, s42, 16
    s_cmp_ge_u32 s42, 16
    s_cbranch_scc1 L_exit
    s_lshl_b32 s44, s41, 2
    s_lshr_b32 s44, 0x76540213, s44
    s_and_b32 s44, s44, 7
    s_lshl4_add_u32 s43, s44, s42
    s_lshl_b32 s44, s43, 10
    s_lshl_b32 s45, s43, 3
    v_and_b32 v3, 255, v0
    v_and_b32 v5, 60, v0
    v_add_u32 v5, v5, v9
    v_lshl_add_u32 v3, v3, 2, s44
    v_mov_b32 v14, 0
    v_mov_b32 v15, 0
    v_and_b32 v8, 120, v0
    v_add_u32 v8, 148496, v8
    ds_write_b64 v8, v[14:15]
    s_and_b32 s46, s40, 3
    s_lshl_b32 s46, s46, 17
    s_add_u32 s46, s46, s45
    s_add_u32 s46, s46, 2048
    v_lshl_add_u32 v5, v5, 10, s46
    v_add_u32 v7, 0x80000, v5
    s_lshl4_add_u32 s46, s40, s42
    s_and_b32 s46, s46, 63
    s_lshl_b32 s46, s46, 15
    s_add_u32 s46, s46, s45
    v_lshl_add_u32 v6, v9, 10, s46
    s_cmp_lt_u32 s40, 4
    s_waitcnt lgkmcnt(0)
    s_load_dwordx2 s[86:87], s[18:19], s45
    s_load_dwordx2 s[88:89], s[20:21], s45
    global_load_dword v10, v3, s[10:11]
    global_load_dword v11, v3, s[12:13]
    s_barrier
    global_load_dword v12, v3, s[14:15]
    global_load_dword v13, v3, s[16:17]
    s_barrier
    s_cbranch_scc1 L_conv0b
    s_mov_b32 exec_hi, 0
    global_load_dword v17, v6, s[8:9]
    s_mov_b32 exec_hi, -1
    global_load_dwordx2 v[18:19], v5, s[8:9] offset:-2048
    global_load_dwordx2 v[20:21], v5, s[8:9] offset:2048
    s_barrier
    global_load_dwordx2 v[22:23], v7, s[8:9] offset:-2048
    global_load_dwordx2 v[24:25], v7, s[8:9] offset:2048
    s_branch L_conv1
L_conv0b:
    s_barrier
    s_branch L_conv0
L_ffnh:
    s_cmp_lg_u32 s41, 0
    s_cbranch_scc1 L_ffn
    s_lshl_b32 s44, s42, 8
    v_add_lshl_u32 v3, v0, s44, 10
    v_and_b32 v3, 0x1fffff, v3
    s_cmp_lt_u32 s40, 4
    s_cbranch_scc0 L_root
    s_waitcnt lgkmcnt(0)
    global_load_dword v4, v3, s[8:9] offset:384
    s_endpgm
L_router2:
    ds_write_b32 v6, v6
    s_lshl_b32 s45, s45, 2
    v_bfe_u32 v7, v9, 2, 2
    s_lshl_b32 s44, s40, 4
    v_lshl_add_u32 v11, v7, 2, s44
    v_add_u32 v7, s45, v7
    v_sub_u32 v7, 0xfff, v7
    s_mov_b32 s46, 0xffff0000
    s_lshl_b32 s44, s43, 7
    v_and_b32 v12, 60, v9
    v_add_lshl_u32 v12, v12, v9, 2
    v_lshl_add_u32 v8, v9, 3, s44
    s_add_u32 s44, s44, 16384
    v_mov_b32 v10, s44
    s_waitcnt lgkmcnt(0)
    s_barrier
    s_load_dword s80, s[38:39], 28672
    s_lshl_b32 s61, s41, 3
    s_sub_u32 s61, s61, 8
    s_max_i32 s62, s61, 0
    s_lshl_b32 s62, s62, 6
    v_and_b32 v120, 3, v9
    v_lshl_add_u32 v120, v120, 7, s62
    s_and_b32 s62, s40, 3
    s_lshl2_add_u32 s62, s42, s62
    s_lshl_b32 s62, s62, 4
    s_add_u32 s62, s62, 4
    v_bfe_u32 v121, v9, 4, 1
    v_bfe_u32 v122, v9, 2, 2
    v_lshl_add_u32 v121, v121, 3, v122
    v_add_u32 v121, s62, v121
    s_movk_i32 s62, 3584
    v_mad_u32_u24 v120, v121, s62, v120
    s_cmp_ge_u32 s40, 4
    s_cselect_b64 s[62:63], s[28:29], s[26:27]
    s_cmp_lg_u32 s41, 0
    s_cselect_b32 exec_lo, 4294967295, 1
    s_mov_b32 exec_hi, 0
    global_load_dword v123, v120, s[62:63]
    s_mov_b64 exec, -1
    s_waitcnt vmcnt(4)
    v_dot2_f32_bf16 v40, v16, v32, 0
    v_dot2_f32_bf16 v44, v16, v36, 0
    v_dot2_f32_bf16 v40, v17, v33, v40
    v_dot2_f32_bf16 v44, v17, v37, v44
    v_dot2_f32_bf16 v40, v18, v34, v40
    v_dot2_f32_bf16 v44, v18, v38, v44
    v_dot2_f32_bf16 v40, v19, v35, v40
    v_dot2_f32_bf16 v44, v19, v39, v44
    s_waitcnt vmcnt(3)
    v_dot2_f32_bf16 v41, v20, v32, 0
    v_dot2_f32_bf16 v45, v20, v36, 0
    v_dot2_f32_bf16 v41, v21, v33, v41
    v_dot2_f32_bf16 v45, v21, v37, v45
    v_dot2_f32_bf16 v41, v22, v34, v41
    v_dot2_f32_bf16 v45, v22, v38, v45
    v_dot2_f32_bf16 v41, v23, v35, v41
    v_dot2_f32_bf16 v45, v23, v39, v45
    v_add_f32_dpp v48, v40, v40 row_ror:8 row_mask:0xf bank_mask:0x3
    v_add_f32_dpp v50, v44, v44 row_ror:8 row_mask:0xf bank_mask:0x3
    s_waitcnt vmcnt(2)
    v_dot2_f32_bf16 v42, v24, v32, 0
    v_dot2_f32_bf16 v46, v24, v36, 0
    v_dot2_f32_bf16 v42, v25, v33, v42
    v_dot2_f32_bf16 v46, v25, v37, v46
    v_dot2_f32_bf16 v42, v26, v34, v42
    v_dot2_f32_bf16 v46, v26, v38, v46
    v_dot2_f32_bf16 v42, v27, v35, v42
    v_dot2_f32_bf16 v46, v27, v39, v46
    v_add_f32_dpp v49, v41, v41 row_ror:8 row_mask:0xf bank_mask:0x3
    v_add_f32_dpp v51, v45, v45 row_ror:8 row_mask:0xf bank_mask:0x3
    s_waitcnt vmcnt(1)
    v_dot2_f32_bf16 v43, v28, v32, 0
    v_dot2_f32_bf16 v47, v28, v36, 0
    v_dot2_f32_bf16 v43, v29, v33, v43
    v_dot2_f32_bf16 v47, v29, v37, v47
    v_dot2_f32_bf16 v43, v30, v34, v43
    v_dot2_f32_bf16 v47, v30, v38, v47
    v_dot2_f32_bf16 v43, v31, v35, v43
    v_dot2_f32_bf16 v47, v31, v39, v47
    v_add_f32_dpp v48, v42, v42 row_ror:8 row_mask:0xf bank_mask:0xc
    v_add_f32_dpp v50, v46, v46 row_ror:8 row_mask:0xf bank_mask:0xc
    s_nop 0
    v_add_f32_dpp v52, v48, v48 row_shl:4 row_mask:0xf bank_mask:0x5
    v_add_f32_dpp v49, v43, v43 row_ror:8 row_mask:0xf bank_mask:0xc
    v_add_f32_dpp v51, v47, v47 row_ror:8 row_mask:0xf bank_mask:0xc
    v_add_f32_dpp v53, v50, v50 row_shl:4 row_mask:0xf bank_mask:0x5
    v_add_f32_dpp v52, v49, v49 row_shr:4 row_mask:0xf bank_mask:0xa
    s_nop 0
    v_add_f32_dpp v53, v51, v51 row_shr:4 row_mask:0xf bank_mask:0xa
    s_nop 1
    v_permlane32_swap_b32 v52, v53
    v_add_f32 v52, v52, v53
    v_mov_b32 v53, v52
    s_nop 1
    v_permlane16_swap_b32 v52, v53
    v_add_f32 v52, v52, v53
    s_nop 1
    v_add_f32_dpp v52, v52, v52 quad_perm:[1,0,3,2] row_mask:0xf bank_mask:0xf
    s_nop 1
    v_add_f32_dpp v52, v52, v52 quad_perm:[2,3,0,1] row_mask:0xf bank_mask:0xf
    v_ashrrev_i32 v53, 31, v52
    v_cvt_pk_bf16_f32 v54, v52, v52
    v_or_b32 v53, 0x80000000, v53
    v_xor_b32 v53, v54, v53
    v_and_or_b32 v53, v53, s46, v7
    s_mov_b64 exec, 0x1111
    ds_max_u32 v6, v53
    s_lshl_b64 exec, exec, 32
    ds_write_b32 v11, v52 offset:64
    s_mov_b64 exec, -1
    s_cmp_ge_u32 s40, 2
    s_waitcnt lgkmcnt(0)
    s_barrier
    s_cbranch_scc1 L_done
    ds_read_b32 v54, v6
    ds_read2_b32 v[52:53], v12 offset0:16 offset1:20
    s_mul_i32 s80, s80, 0x9e3779b1
    s_add_u32 s80, s80, 0x7f4a7c15
    s_or_b32 s80, s80, 1
    v_mov_b32 v55, s80
    s_cmp_lg_u32 s40, 0
    s_cbranch_scc1 L_router_g
    s_mov_b64 exec, 1
    s_waitcnt lgkmcnt(1)
    global_store_dwordx2 v10, v[54:55], s[38:39] sc1
    s_branch L_done
L_router_g:
    s_waitcnt lgkmcnt(0)
    v_cvt_pk_bf16_f32 v53, v52, v53
    v_lshlrev_b32 v52, 16, v53
    v_and_b32 v53, 0xffff0000, v53
    v_mul_f32 v52, 3216550459, v52
    v_mul_f32 v53, 3216550459, v53
    v_exp_f32 v52, v52
    v_exp_f32 v53, v53
    s_mov_b64 exec, 0xffff
    v_add_f32 v52, 1.0, v52
    v_add_f32 v53, 1.0, v53
    v_rcp_f32 v52, v52
    v_rcp_f32 v53, v53
    s_nop 0
    v_cvt_pk_bf16_f32 v54, v52, v53
    global_store_dwordx2 v8, v[54:55], s[38:39] sc1
    s_mov_b64 exec, -1
    s_cmp_eq_u32 s41, 0
    s_cbranch_scc1 L_done
    s_add_u32 s61, s61, s42
    s_lshl_b32 s61, s61, 15
    v_lshl_add_u32 v120, v9, 9, s61
    global_load_dword v123, v120, s[30:31] offset:0
    global_load_dword v123, v120, s[30:31] offset:128
    global_load_dword v123, v120, s[30:31] offset:256
    global_load_dword v123, v120, s[30:31] offset:384
    s_branch L_done
L_ffn:
    s_lshl_b32 s61, s41, 3
    s_sub_u32 s61, s61, 8
    s_add_u32 s43, s61, s42
    s_sub_u32 s43, s43, 8
    s_lshr_b32 s44, s40, 1
    s_lshl_b32 s45, s43, 1
    s_and_b32 s45, s45, 2
    s_xor_b32 s44, s44, s45
    v_lshrrev_b32 v3, 4, v9
    v_bfe_u32 v4, v9, 2, 2
    v_and_b32 v5, 3, v9
    v_lshl_add_u32 v6, v4, 2, v3
    s_lshl_b32 s45, s44, 4
    v_add_u32 v6, s45, v6
    s_movk_i32 s46, 0x7000
    s_lshl_b32 s47, s43, 6
    s_add_u32 s47, s47, 3584
    v_lshl_add_u32 v7, v5, 4, s47
    v_mad_u32_u24 v7, v6, s46, v7
    v_add_u32 v8, 10752, v7
    v_add_u32 v10, 21504, v7
    s_bitcmp1_b32 s40, 0
    s_waitcnt lgkmcnt(0)
    s_cselect_b64 s[48:49], s[28:29], s[26:27]
    s_load_dword s80, s[38:39], 28672
    s_cmp_ge_u32 s40, 4
    s_cbranch_scc1 L_ffn_o1
    global_load_dwordx4 v[16:19], v7, s[48:49] offset:-3584
    global_load_dwordx4 v[20:23], v7, s[48:49] offset:0
    global_load_dwordx4 v[24:27], v7, s[48:49] offset:3584
    global_load_dwordx4 v[28:31], v8, s[48:49] offset:-3584
L_ffn_o1:
    s_lshl_b32 s45, s43, 15
    s_and_b32 s56, s40, 3
    s_lshl_b32 s46, s56, 8
    s_add_u32 s45, s45, s46
    s_add_u32 s45, s45, 4096
    v_and_b32 v11, 15, v9
    v_lshl_add_u32 v12, v11, 4, s45
    v_lshl_add_u32 v12, v3, 13, v12
    v_lshlrev_b32 v114, 7, v9
    v_add_u32 v114, 16384, v114
    s_barrier
    s_cmp_lt_u32 s40, 4
    s_cbranch_scc1 L_ffn_o2
    global_load_dwordx4 v[16:19], v7, s[48:49] offset:-3584
    global_load_dwordx4 v[20:23], v7, s[48:49] offset:0
    global_load_dwordx4 v[24:27], v7, s[48:49] offset:3584
    global_load_dwordx4 v[28:31], v8, s[48:49] offset:-3584
L_ffn_o2:
    s_barrier
    s_cmp_lg_u32 s40, 0
    global_load_dwordx4 v[32:35], v8, s[48:49] offset:0
    global_load_dwordx4 v[36:39], v8, s[48:49] offset:3584
    global_load_dwordx4 v[40:43], v10, s[48:49] offset:-3584
    global_load_dwordx4 v[44:47], v10, s[48:49] offset:0
    s_cbranch_scc1 L_ffn_b3
    global_load_dwordx2 v[112:113], v114, s[38:39] sc1
L_ffn_b3:
    s_mov_b32 s50, 0x05040100
    s_mov_b32 s51, 0x07060302
    v_lshlrev_b32 v6, 4, v6
    s_and_b32 s45, s40, 1
    s_mul_i32 s45, s45, 2560
    s_lshl_b32 s46, s44, 4
    s_add_u32 s45, s45, s46
    v_lshl_add_u32 v14, v4, 2, s45
    s_movk_i32 s46, 80
    v_mad_u32_u24 v14, v5, s46, v14
    v_add_u32 v125, 1280, v14
    v_mul_u32_u24 v15, 80, v9
    s_lshl_b32 s45, s40, 7
    s_add_u32 s45, s45, 8192
    v_bfe_u32 v7, v9, 2, 3
    v_lshl_add_u32 v7, v5, 3, v7
    v_lshl_add_u32 v7, v7, 1, s45
    v_lshl_add_u32 v8, v3, 4, s45
    s_lshl_b32 s45, s43, 11
    s_lshl_b32 s46, s56, 9
    s_add_u32 s45, s45, s46
    s_add_u32 s45, s45, 32768
    v_lshl_add_u32 v10, v11, 4, s45
    v_mov_b32 v116, 0
    v_lshlrev_b32 v118, 4, v9
    s_mov_b32 s54, 0x00f0000f
    s_mov_b32 s55, 0xf0000f00
    s_waitcnt lgkmcnt(0)
    s_mul_i32 s80, s80, 0x9e3779b1
    s_add_u32 s80, s80, 0x7f4a7c15
    s_or_b32 s80, s80, 1
    s_waitcnt vmcnt(4)
    v_perm_b32 v64, v20, v16, s50
    v_perm_b32 v65, v28, v24, s50
    v_perm_b32 v68, v20, v16, s51
    v_perm_b32 v69, v28, v24, s51
    v_perm_b32 v72, v21, v17, s50
    v_perm_b32 v73, v29, v25, s50
    v_perm_b32 v76, v21, v17, s51
    v_perm_b32 v77, v29, v25, s51
    v_perm_b32 v80, v22, v18, s50
    v_perm_b32 v81, v30, v26, s50
    v_perm_b32 v84, v22, v18, s51
    v_perm_b32 v85, v30, v26, s51
    v_perm_b32 v88, v23, v19, s50
    v_perm_b32 v89, v31, v27, s50
    v_perm_b32 v92, v23, v19, s51
    v_perm_b32 v93, v31, v27, s51
    s_cmp_lg_u32 s40, 0
    s_waitcnt vmcnt(0)
    s_cbranch_scc1 L_ffn_w
    v_cmp_ne_u32 vcc, s80, v113
    s_cbranch_vccz L_ffn_pk_x
    s_mov_b32 s58, 0
L_ffn_pk:
    v_mov_b32 v13, 0
    global_load_dword v115, v13, s[36:37] sc1
    global_load_dwordx2 v[112:113], v114, s[38:39] sc1
    s_add_u32 s58, s58, 1
    s_waitcnt vmcnt(0)
    v_readfirstlane_b32 s81, v115
    s_cmp_lg_u32 s81, 0
    s_cselect_b32 s80, s81, s80
    v_cmp_ne_u32 vcc, s80, v113
    s_cmp_gt_u32 s58, 1048576
    s_cbranch_scc1 L_ffn_pk_x
    s_cbranch_vccnz L_ffn_pk
L_ffn_pk_x:
    s_nop 1
    v_max_u32_dpp v112, v112, v112 row_shr:1 row_mask:0xf bank_mask:0xf
    s_nop 1
    v_max_u32_dpp v112, v112, v112 row_shr:2 row_mask:0xf bank_mask:0xf
    s_nop 1
    v_max_u32_dpp v112, v112, v112 row_shr:4 row_mask:0xf bank_mask:0xf
    s_nop 1
    v_max_u32_dpp v112, v112, v112 row_shr:8 row_mask:0xf bank_mask:0xf
    s_nop 1
    v_max_u32_dpp v112, v112, v112 row_bcast:15 row_mask:0xa bank_mask:0xf
    s_nop 1
    v_max_u32_dpp v112, v112, v112 row_bcast:31 row_mask:0xc bank_mask:0xf
    s_nop 0
    v_readlane_b32 s52, v112, 63
    s_not_b32 s53, s52
    s_and_b32 s53, s53, 0x7ff
    s_lshl_b32 s53, s53, 10
    v_add_u32 v119, s53, v118
    global_load_dwordx4 v[120:123], v119, s[8:9]
    s_barrier
    s_xor_b32 s47, s52, 0x80000000
    s_not_b32 s53, s52
    s_bitcmp1_b32 s52, 31
    s_cselect_b32 s46, s47, s53
    s_and_b32 s46, s46, 0xffff0000
    v_mov_b32 v124, 3216550459
    v_mul_f32 v124, s46, v124
    v_exp_f32 v124, v124
    s_nop 0
    v_add_f32 v124, 1.0, v124
    v_rcp_f32 v124, v124
    s_nop 0
    ds_write_b32 v116, v124 offset:13312
    v_perm_b32 v66, v36, v32, s50
    v_perm_b32 v67, v44, v40, s50
    v_perm_b32 v70, v36, v32, s51
    v_perm_b32 v71, v44, v40, s51
    v_perm_b32 v74, v37, v33, s50
    v_perm_b32 v75, v45, v41, s50
    v_perm_b32 v78, v37, v33, s51
    v_perm_b32 v79, v45, v41, s51
    v_perm_b32 v82, v38, v34, s50
    v_perm_b32 v83, v46, v42, s50
    v_perm_b32 v86, v38, v34, s51
    v_perm_b32 v87, v46, v42, s51
    v_perm_b32 v90, v39, v35, s50
    v_perm_b32 v91, v47, v43, s50
    v_perm_b32 v94, v39, v35, s51
    v_perm_b32 v95, v47, v43, s51
    s_waitcnt vmcnt(0)
    ds_write_b128 v118, v[120:123] offset:12288
    s_waitcnt lgkmcnt(0)
    s_branch L_ffn_bar
L_ffn_w:
    s_cmp_lt_u32 s40, 4
    s_cbranch_scc1 L_ffn_w2
    global_load_dwordx4 v[128:131], v12, s[30:31] offset:-4096
    global_load_dwordx4 v[132:135], v12, s[30:31] offset:-3072
    global_load_dwordx4 v[136:139], v12, s[30:31] offset:-2048
L_ffn_w2:
    v_perm_b32 v66, v36, v32, s50
    v_perm_b32 v67, v44, v40, s50
    v_perm_b32 v70, v36, v32, s51
    v_perm_b32 v71, v44, v40, s51
    v_perm_b32 v74, v37, v33, s50
    v_perm_b32 v75, v45, v41, s50
    v_perm_b32 v78, v37, v33, s51
    v_perm_b32 v79, v45, v41, s51
    v_perm_b32 v82, v38, v34, s50
    v_perm_b32 v83, v46, v42, s50
    v_perm_b32 v86, v38, v34, s51
    v_perm_b32 v87, v46, v42, s51
    v_perm_b32 v90, v39, v35, s50
    v_perm_b32 v91, v47, v43, s50
    v_perm_b32 v94, v39, v35, s51
    v_perm_b32 v95, v47, v43, s51
    s_barrier
    s_cbranch_scc1 L_ffn_bar
    global_load_dwordx4 v[140:143], v12, s[30:31] offset:-1024
    global_load_dwordx4 v[144:147], v12, s[30:31] offset:0
    global_load_dwordx4 v[148:151], v12, s[30:31] offset:1024
    global_load_dwordx4 v[152:155], v12, s[30:31] offset:2048
    global_load_dwordx4 v[156:159], v12, s[30:31] offset:3072
    s_setprio 1
L_ffn_bar:
    s_barrier
    ds_read_b128 v[16:19], v6 offset:12288
    ds_read_b32 v117, v116 offset:13312
    s_cmp_lt_u32 s40, 4
    s_waitcnt lgkmcnt(1)
    v_mfma_f32_16x16x32_bf16 v[20:23], v[16:19], v[64:67], 0
    v_mfma_f32_16x16x32_bf16 v[24:27], v[16:19], v[68:71], 0
    v_mfma_f32_16x16x32_bf16 v[28:31], v[16:19], v[72:75], 0
    v_mfma_f32_16x16x32_bf16 v[32:35], v[16:19], v[76:79], 0
    v_mfma_f32_16x16x32_bf16 v[36:39], v[16:19], v[80:83], 0
    v_mfma_f32_16x16x32_bf16 v[40:43], v[16:19], v[84:87], 0
    v_mfma_f32_16x16x32_bf16 v[44:47], v[16:19], v[88:91], 0
    v_mfma_f32_16x16x32_bf16 v[48:51], v[16:19], v[92:95], 0
    s_mov_b64 exec, s[54:55]
    s_nop 0
    ds_write2_b32 v14, v20, v24 offset0:0 offset1:80
    s_nop 0
    ds_write2_b32 v14, v28, v32 offset0:160 offset1:240
    s_nop 0
    ds_write2_b32 v125, v36, v40 offset0:0 offset1:80
    s_nop 0
    ds_write2_b32 v125, v44, v48 offset0:160 offset1:240
    s_mov_b64 exec, -1
    s_cbranch_scc1 L_ffn_b2
    s_waitcnt vmcnt(4)
    v_perm_b32 v160, v132, v128, s50
    v_perm_b32 v161, v140, v136, s50
    v_perm_b32 v164, v132, v128, s51
    v_perm_b32 v165, v140, v136, s51
    v_perm_b32 v168, v133, v129, s50
    v_perm_b32 v169, v141, v137, s50
    v_perm_b32 v172, v133, v129, s51
    v_perm_b32 v173, v141, v137, s51
    v_perm_b32 v176, v134, v130, s50
    v_perm_b32 v177, v142, v138, s50
    v_perm_b32 v180, v134, v130, s51
    v_perm_b32 v181, v142, v138, s51
    v_perm_b32 v184, v135, v131, s50
    v_perm_b32 v185, v143, v139, s50
    v_perm_b32 v188, v135, v131, s51
    v_perm_b32 v189, v143, v139, s51
L_ffn_b2:
    s_waitcnt lgkmcnt(0)
    s_barrier
    s_cbranch_scc1 L_done
    ds_read_b128 v[20:23], v15
    ds_read_b128 v[24:27], v15 offset:16
    ds_read_b128 v[28:31], v15 offset:32
    ds_read_b128 v[32:35], v15 offset:48
    s_waitcnt lgkmcnt(2)
    v_pk_add_f32 v[20:21], v[20:21], v[22:23]
    v_pk_add_f32 v[24:25], v[24:25], v[26:27]
    s_waitcnt lgkmcnt(0)
    v_pk_add_f32 v[28:29], v[28:29], v[30:31]
    v_pk_add_f32 v[32:33], v[32:33], v[34:35]
    v_pk_add_f32 v[20:21], v[20:21], v[24:25]
    v_pk_add_f32 v[28:29], v[28:29], v[32:33]
    v_pk_add_f32 v[20:21], v[20:21], v[28:29]
    v_add_f32 v20, v20, v21
    v_mov_b32 v21, v20
    s_nop 1
    v_permlane32_swap_b32 v20, v21
    v_mul_f32 v22, 3216550459, v20
    v_exp_f32 v22, v22
    v_mul_f32 v20, v20, v21
    v_add_f32 v22, 1.0, v22
    v_rcp_f32 v22, v22
    v_mul_f32 v20, v20, v117
    v_mul_f32 v20, v20, v22
    v_cvt_pk_bf16_f32 v20, v20, v20
    ds_write_b16 v7, v20
    ds_read_b128 v[16:19], v8
    s_waitcnt vmcnt(0)
    v_perm_b32 v162, v148, v144, s50
    v_perm_b32 v163, v156, v152, s50
    v_perm_b32 v166, v148, v144, s51
    v_perm_b32 v167, v156, v152, s51
    v_perm_b32 v170, v149, v145, s50
    v_perm_b32 v171, v157, v153, s50
    v_perm_b32 v174, v149, v145, s51
    v_perm_b32 v175, v157, v153, s51
    v_perm_b32 v178, v150, v146, s50
    v_perm_b32 v179, v158, v154, s50
    v_perm_b32 v182, v150, v146, s51
    v_perm_b32 v183, v158, v154, s51
    v_perm_b32 v186, v151, v147, s50
    v_perm_b32 v187, v159, v155, s50
    v_perm_b32 v190, v151, v147, s51
    v_perm_b32 v191, v159, v155, s51
    s_waitcnt lgkmcnt(0)
    s_nop 0
    v_mfma_f32_16x16x32_bf16 v[20:23], v[16:19], v[160:163], 0
    v_mfma_f32_16x16x32_bf16 v[24:27], v[16:19], v[164:167], 0
    v_mfma_f32_16x16x32_bf16 v[28:31], v[16:19], v[168:171], 0
    v_mfma_f32_16x16x32_bf16 v[32:35], v[16:19], v[172:175], 0
    v_mfma_f32_16x16x32_bf16 v[36:39], v[16:19], v[176:179], 0
    v_mfma_f32_16x16x32_bf16 v[40:43], v[16:19], v[180:183], 0
    v_mfma_f32_16x16x32_bf16 v[44:47], v[16:19], v[184:187], 0
    v_mfma_f32_16x16x32_bf16 v[48:51], v[16:19], v[188:191], 0
    s_mov_b64 exec, 0xffff
    v_or_b32 v52, 1, v20
    v_or_b32 v53, 1, v24
    v_or_b32 v54, 1, v28
    v_or_b32 v55, 1, v32
    global_store_dwordx4 v10, v[52:55], s[38:39] sc1
    v_or_b32 v56, 1, v36
    v_or_b32 v57, 1, v40
    v_or_b32 v58, 1, v44
    v_or_b32 v59, 1, v48
    global_store_dwordx4 v10, v[56:59], s[38:39] offset:256 sc1
    s_branch L_done
.p2align 12
L_conv0:
    s_mul_i32 s48, s40, 9216
    s_mul_i32 s49, s40, 6912
    s_mov_b32 m0, s48
    s_add_u32 s50, s49, 73728
    v_mov_b32 v72, 0x3c00
    ds_write_addtid_b32 v72
    s_add_u32 s49, s49, 14848
    s_mov_b32 s52, 0x7fff7fff
    s_lshl_b32 s85, s40, 4
    v_and_b32 v7, 15, v9
    v_and_b32 v6, 48, v9
    s_movk_i32 s46, 288
    v_mad_u32_u24 v40, v7, s46, v6
    v_add_u32 v40, s48, v40
    v_lshlrev_b32 v43, 2, v7
    s_mov_b32 s60, 828015766
    s_mov_b32 s61, 729250816
    v_lshrrev_b64 v[44:45], v43, s[60:61]
    v_and_b32 v44, 15, v44
    v_mad_u32_u24 v41, v44, s46, v6
    s_add_u32 s47, s50, 0
    v_add_u32 v41, s47, v41
    s_mov_b32 s60, 1426527098
    s_mov_b32 s61, 1149641321
    v_lshrrev_b64 v[44:45], v43, s[60:61]
    v_and_b32 v44, 15, v44
    v_mad_u32_u24 v42, v44, s46, v6
    s_add_u32 s47, s50, 3744
    v_add_u32 v42, s47, v42
    v_lshrrev_b32 v8, 4, v0
    v_and_b32 v18, 15, v0
    s_movk_i32 s46, 1216
    v_lshlrev_b32 v18, 3, v18
    v_mad_u32_u24 v8, v8, s46, v18
    v_add_u32 v8, 129032, v8
    v_mov_b32 v18, 0
    v_mov_b32 v19, 0
    ds_write_b64 v8, v[18:19]
    s_add_u32 s46, s40, 148496
    v_mov_b32 v26, s46
    s_add_u32 s50, s50, 27648
    v_lshl_add_u32 v20, v7, 4, s50
    v_bfe_u32 v25, v9, 4, 1
    v_lshl_add_u32 v24, v25, 3, v20
    v_mul_u32_u24 v25, 0x0202, v25
    v_add_u32 v25, 0x03020100, v25
    v_lshrrev_b32 v31, 5, v9
    v_lshl_add_u32 v24, v31, 9, v24
    v_lshl_add_u32 v20, v6, 5, v20
    v_add_u32 v20, 2072, v20
    v_and_b32 v22, 3, v9
    v_lshl_add_u32 v27, v22, 3, s50
    v_bfe_u32 v23, v9, 2, 2
    v_lshrrev_b32 v8, 4, v9
    v_sub_u32 v22, v22, v23
    v_lshlrev_b32 v23, 3, v8
    v_sub_u32 v22, v22, v23
    s_add_u32 s46, s50, 224
    v_lshl_add_u32 v22, v22, 3, s46
    s_mul_i32 s46, s40, 4864
    s_add_u32 s46, s46, 129104
    v_and_b32 v23, 7, v9
    v_lshl_add_u32 v23, v23, 3, s46
    v_lshl_add_u32 v23, v8, 4, v23
    v_and_b32 v21, 1, v9
    s_movk_i32 s46, 0
    v_mad_u32_u24 v23, v21, s46, v23
    v_bfe_u32 v21, v9, 3, 1
    s_movk_i32 s46, 2432
    v_mad_u32_u24 v23, v21, s46, v23
    s_lshl_b32 s46, s40, 2
    v_lshlrev_b32 v21, 3, v21
    v_xor_b32 v21, s46, v21
    v_lshl_add_u32 v21, v9, 4, v21
    s_add_u32 s46, s46, 1024
    v_and_b32 v28, 15, v9
    v_mul_u32_u24 v28, 4288, v28
    v_add_u32 v28, s46, v28
    v_mov_b32 v29, 1
    v_mov_b32 v31, 0
    v_mov_b32 v30, 148560
    s_mov_b32 s54, 16843009
    s_mov_b32 s55, 16843009
    v_subrev_u32 v16, 1, v9
    v_ashrrev_i32 v16, 31, v16
    s_waitcnt vmcnt(2)
    s_setprio 3
    v_lshlrev_b32 v10, 16, v10
    s_waitcnt lgkmcnt(0)
    s_lshr_b64 s[86:87], s[86:87], s85
    s_lshl_b32 s86, s86, 16
    v_mov_b32 v14, 1069066811
    v_mul_f32 v10, v14, v10
    v_mul_f32 v14, s86, v14
    v_exp_f32 v14, v14
    v_exp_f32 v10, v10
    v_lshlrev_b32 v11, 16, v11
    v_mul_f32 v11, 1042479491, v11
    v_cvt_pk_bf16_f32 v10, v10, v14
    v_and_b32 v14, 0xffff0000, v10
    v_lshlrev_b32 v10, 16, v10
    v_mul_f32 v11, v11, v14
    v_mul_f32 v10, v10, v14
    v_mul_f32 v55, 0x41000000, v11
    v_mul_f32 v54, 0xc138aa3b, v10
    v_fract_f32 v55, v55
    v_exp_f32 v54, v54
    v_cos_f32 v52, v55
    v_sin_f32 v53, v55
    s_nop 0
    v_pk_mul_f32 v[52:53], v[52:53], v[54:55] op_sel_hi:[1,0]
    v_cvt_pk_f16_f32 v63, v52, v53
    v_pk_mul_f32 v[58:59], v[52:53], v[52:53] op_sel:[0,0] op_sel_hi:[0,1]
    v_pk_fma_f32 v[52:53], v[52:53], v[52:53], v[58:59] op_sel:[1,1,0] op_sel_hi:[1,0,1] neg_lo:[1,0,0]
    ds_write_addtid_b32 v63 offset:288
    v_cvt_pk_f16_f32 v64, v52, v53
    v_pk_mul_f32 v[58:59], v[52:53], v[52:53] op_sel:[0,0] op_sel_hi:[0,1]
    v_pk_fma_f32 v[52:53], v[52:53], v[52:53], v[58:59] op_sel:[1,1,0] op_sel_hi:[1,0,1] neg_lo:[1,0,0]
    ds_write_addtid_b32 v64 offset:576
    v_pk_mul_f16 v75, v63, v64 op_sel:[0,0] op_sel_hi:[1,0]
    v_pk_fma_f16 v75, v63, v64, v75 op_sel:[1,1,0] op_sel_hi:[0,1,1] neg_lo:[1,0,0]
    ds_write_addtid_b32 v75 offset:864
    v_mul_f32 v10, 3216550459, v10
    v_fract_f32 v11, v11
    v_exp_f32 v10, v10
    v_cvt_pk_f16_f32 v65, v52, v53
    v_pk_mul_f32 v[58:59], v[52:53], v[52:53] op_sel:[0,0] op_sel_hi:[0,1]
    v_pk_fma_f32 v[52:53], v[52:53], v[52:53], v[58:59] op_sel:[1,1,0] op_sel_hi:[1,0,1] neg_lo:[1,0,0]
    ds_write_addtid_b32 v65 offset:1152
    v_pk_mul_f16 v77, v63, v65 op_sel:[0,0] op_sel_hi:[1,0]
    v_pk_mul_f16 v78, v64, v65 op_sel:[0,0] op_sel_hi:[1,0]
    v_pk_fma_f16 v77, v63, v65, v77 op_sel:[1,1,0] op_sel_hi:[0,1,1] neg_lo:[1,0,0]
    v_pk_fma_f16 v78, v64, v65, v78 op_sel:[1,1,0] op_sel_hi:[0,1,1] neg_lo:[1,0,0]
    ds_write_addtid_b32 v77 offset:1440
    ds_write_addtid_b32 v78 offset:1728
    v_cos_f32 v50, v11
    v_sin_f32 v51, v11
    v_mul_f32 v50, v50, v10
    v_pk_mul_f16 v79, v75, v65 op_sel:[0,0] op_sel_hi:[1,0]
    v_pk_fma_f16 v79, v75, v65, v79 op_sel:[1,1,0] op_sel_hi:[0,1,1] neg_lo:[1,0,0]
    ds_write_addtid_b32 v79 offset:2016
    v_mul_f32 v51, v51, v10
    v_cvt_pk_f16_f32 v60, v50, v51
    s_waitcnt vmcnt(0)
    v_and_b32 v46, s52, v12
    v_cvt_pk_f16_f32 v66, v52, v53
    v_pk_mul_f32 v[58:59], v[52:53], v[52:53] op_sel:[0,0] op_sel_hi:[0,1]
    v_pk_fma_f32 v[52:53], v[52:53], v[52:53], v[58:59] op_sel:[1,1,0] op_sel_hi:[1,0,1] neg_lo:[1,0,0]
    ds_write_addtid_b32 v66 offset:2304
    v_pk_mul_f16 v81, v63, v66 op_sel:[0,0] op_sel_hi:[1,0]
    v_pk_mul_f16 v82, v64, v66 op_sel:[0,0] op_sel_hi:[1,0]
    v_pk_fma_f16 v81, v63, v66, v81 op_sel:[1,1,0] op_sel_hi:[0,1,1] neg_lo:[1,0,0]
    v_pk_fma_f16 v82, v64, v66, v82 op_sel:[1,1,0] op_sel_hi:[0,1,1] neg_lo:[1,0,0]
    ds_write_addtid_b32 v81 offset:2592
    ds_write_addtid_b32 v82 offset:2880
    v_and_b32 v47, s52, v13
    v_pk_max_u16 v46, v46, v47
    v_pk_max_u16 v46, v46, v46 op_sel:[0,1] op_sel_hi:[1,0]
    v_pk_mul_f16 v83, v75, v66 op_sel:[0,0] op_sel_hi:[1,0]
    v_pk_mul_f16 v84, v65, v66 op_sel:[0,0] op_sel_hi:[1,0]
    v_pk_fma_f16 v83, v75, v66, v83 op_sel:[1,1,0] op_sel_hi:[0,1,1] neg_lo:[1,0,0]
    v_pk_fma_f16 v84, v65, v66, v84 op_sel:[1,1,0] op_sel_hi:[0,1,1] neg_lo:[1,0,0]
    ds_write_addtid_b32 v83 offset:3168
    ds_write_addtid_b32 v84 offset:3456
    v_lshlrev_b32 v12, 16, v12
    v_lshlrev_b32 v13, 16, v13
    v_max_u32_dpp v46, v46, v46 row_shr:1 row_mask:0xf bank_mask:0xf
    v_pk_mul_f16 v85, v77, v66 op_sel:[0,0] op_sel_hi:[1,0]
    v_pk_mul_f16 v86, v78, v66 op_sel:[0,0] op_sel_hi:[1,0]
    v_pk_fma_f16 v85, v77, v66, v85 op_sel:[1,1,0] op_sel_hi:[0,1,1] neg_lo:[1,0,0]
    v_pk_fma_f16 v86, v78, v66, v86 op_sel:[1,1,0] op_sel_hi:[0,1,1] neg_lo:[1,0,0]
    ds_write_addtid_b32 v85 offset:3744
    ds_write_addtid_b32 v86 offset:4032
    v_pk_mul_f32 v[56:57], v[50:51], v[50:51] op_sel:[0,0] op_sel_hi:[0,1]
    s_nop 0
    v_max_u32_dpp v46, v46, v46 row_shr:2 row_mask:0xf bank_mask:0xf
    v_pk_fma_f32 v[50:51], v[50:51], v[50:51], v[56:57] op_sel:[1,1,0] op_sel_hi:[1,0,1] neg_lo:[1,0,0]
    v_pk_mul_f16 v87, v79, v66 op_sel:[0,0] op_sel_hi:[1,0]
    v_pk_fma_f16 v87, v79, v66, v87 op_sel:[1,1,0] op_sel_hi:[0,1,1] neg_lo:[1,0,0]
    ds_write_addtid_b32 v87 offset:4320
    s_nop 0
    v_max_u32_dpp v46, v46, v46 row_shr:4 row_mask:0xf bank_mask:0xf
    v_cvt_pk_f16_f32 v61, v50, v51
    s_nop 0
    v_max_u32_dpp v46, v46, v46 row_shr:8 row_mask:0xf bank_mask:0xf
    v_cvt_pk_f16_f32 v67, v52, v53
    ds_write_addtid_b32 v67 offset:4608
    s_setprio 1
    v_pk_mul_f16 v89, v63, v67 op_sel:[0,0] op_sel_hi:[1,0]
    v_pk_mul_f16 v90, v64, v67 op_sel:[0,0] op_sel_hi:[1,0]
    v_pk_fma_f16 v89, v63, v67, v89 op_sel:[1,1,0] op_sel_hi:[0,1,1] neg_lo:[1,0,0]
    v_pk_fma_f16 v90, v64, v67, v90 op_sel:[1,1,0] op_sel_hi:[0,1,1] neg_lo:[1,0,0]
    ds_write_addtid_b32 v89 offset:4896
    ds_write_addtid_b32 v90 offset:5184
    v_pk_mul_f32 v[58:59], v[52:53], v[52:53] op_sel:[0,0] op_sel_hi:[0,1]
    v_pk_fma_f32 v[52:53], v[52:53], v[52:53], v[58:59] op_sel:[1,1,0] op_sel_hi:[1,0,1] neg_lo:[1,0,0]
    v_pk_mul_f32 v[56:57], v[50:51], v[50:51] op_sel:[0,0] op_sel_hi:[0,1]
    s_nop 0
    v_max_u32_dpp v46, v46, v46 row_bcast:15 row_mask:0xa bank_mask:0xf
    v_pk_mul_f16 v91, v75, v67 op_sel:[0,0] op_sel_hi:[1,0]
    v_pk_mul_f16 v92, v65, v67 op_sel:[0,0] op_sel_hi:[1,0]
    v_pk_fma_f16 v91, v75, v67, v91 op_sel:[1,1,0] op_sel_hi:[0,1,1] neg_lo:[1,0,0]
    v_pk_fma_f16 v92, v65, v67, v92 op_sel:[1,1,0] op_sel_hi:[0,1,1] neg_lo:[1,0,0]
    ds_write_addtid_b32 v91 offset:5472
    ds_write_addtid_b32 v92 offset:5760
    v_cvt_pk_f16_f32 v68, v52, v53
    v_pk_mul_f32 v[58:59], v[52:53], v[52:53] op_sel:[0,0] op_sel_hi:[0,1]
    v_pk_fma_f32 v[50:51], v[50:51], v[50:51], v[56:57] op_sel:[1,1,0] op_sel_hi:[1,0,1] neg_lo:[1,0,0]
    s_nop 0
    v_max_u32_dpp v46, v46, v46 row_bcast:31 row_mask:0xc bank_mask:0xf
    v_pk_mul_f16 v93, v77, v67 op_sel:[0,0] op_sel_hi:[1,0]
    v_pk_mul_f16 v94, v78, v67 op_sel:[0,0] op_sel_hi:[1,0]
    v_pk_fma_f16 v93, v77, v67, v93 op_sel:[1,1,0] op_sel_hi:[0,1,1] neg_lo:[1,0,0]
    v_pk_fma_f16 v94, v78, v67, v94 op_sel:[1,1,0] op_sel_hi:[0,1,1] neg_lo:[1,0,0]
    ds_write_addtid_b32 v93 offset:6048
    ds_write_addtid_b32 v94 offset:6336
    v_pk_fma_f32 v[52:53], v[52:53], v[52:53], v[58:59] op_sel:[1,1,0] op_sel_hi:[1,0,1] neg_lo:[1,0,0]
    v_cvt_pk_f16_f32 v69, v52, v53
    v_cvt_pk_f16_f32 v62, v50, v51
    s_nop 0
    v_readlane_b32 s50, v46, 63
    v_pk_mul_f16 v95, v79, v67 op_sel:[0,0] op_sel_hi:[1,0]
    v_pk_mul_f16 v96, v66, v67 op_sel:[0,0] op_sel_hi:[1,0]
    v_pk_fma_f16 v95, v79, v67, v95 op_sel:[1,1,0] op_sel_hi:[0,1,1] neg_lo:[1,0,0]
    v_pk_fma_f16 v96, v66, v67, v96 op_sel:[1,1,0] op_sel_hi:[0,1,1] neg_lo:[1,0,0]
    ds_write_addtid_b32 v95 offset:6624
    ds_write_addtid_b32 v96 offset:6912
    v_pk_mul_f32 v[58:59], v[52:53], v[52:53] op_sel:[0,0] op_sel_hi:[0,1]
    v_pk_fma_f32 v[52:53], v[52:53], v[52:53], v[58:59] op_sel:[1,1,0] op_sel_hi:[1,0,1] neg_lo:[1,0,0]
    s_and_b32 s50, s50, 0x7f800000
    s_max_u32 s50, s50, 0x07000000
    s_sub_u32 s51, 2239758336, s50
    s_sub_u32 s50, s50, 100663296
    v_mul_f32 v12, s51, v12
    v_mul_f32 v13, s51, v13
    v_pk_mul_f16 v97, v81, v67 op_sel:[0,0] op_sel_hi:[1,0]
    v_pk_mul_f16 v98, v82, v67 op_sel:[0,0] op_sel_hi:[1,0]
    v_pk_fma_f16 v97, v81, v67, v97 op_sel:[1,1,0] op_sel_hi:[0,1,1] neg_lo:[1,0,0]
    v_pk_fma_f16 v98, v82, v67, v98 op_sel:[1,1,0] op_sel_hi:[0,1,1] neg_lo:[1,0,0]
    ds_write_addtid_b32 v97 offset:7200
    ds_write_addtid_b32 v98 offset:7488
    v_cvt_pk_f16_f32 v70, v52, v53
    s_lshr_b64 s[88:89], s[88:89], s85
    s_lshl_b32 s88, s88, 16
    v_add_f32 v15, s88, -1.0
    v_and_b32 v17, v15, v16
    v_pk_mul_f16 v99, v83, v67 op_sel:[0,0] op_sel_hi:[1,0]
    v_pk_mul_f16 v100, v84, v67 op_sel:[0,0] op_sel_hi:[1,0]
    v_pk_fma_f16 v99, v83, v67, v99 op_sel:[1,1,0] op_sel_hi:[0,1,1] neg_lo:[1,0,0]
    v_pk_fma_f16 v100, v84, v67, v100 op_sel:[1,1,0] op_sel_hi:[0,1,1] neg_lo:[1,0,0]
    ds_write_addtid_b32 v99 offset:7776
    ds_write_addtid_b32 v100 offset:8064
    v_mul_f32 v16, s50, v14
    v_cvt_pk_f16_f32 v104, v12, -v13
    v_pk_mul_f16 v101, v85, v67 op_sel:[0,0] op_sel_hi:[1,0]
    v_pk_mul_f16 v102, v86, v67 op_sel:[0,0] op_sel_hi:[1,0]
    v_pk_fma_f16 v101, v85, v67, v101 op_sel:[1,1,0] op_sel_hi:[0,1,1] neg_lo:[1,0,0]
    v_pk_fma_f16 v102, v86, v67, v102 op_sel:[1,1,0] op_sel_hi:[0,1,1] neg_lo:[1,0,0]
    ds_write_addtid_b32 v101 offset:8352
    ds_write_addtid_b32 v102 offset:8640
    v_pk_mul_f16 v103, v87, v67 op_sel:[0,0] op_sel_hi:[1,0]
    v_pk_fma_f16 v103, v87, v67, v103 op_sel:[1,1,0] op_sel_hi:[0,1,1] neg_lo:[1,0,0]
    ds_write_addtid_b32 v103 offset:8928
    s_setprio 0
    s_mov_b32 m0, s49
    ds_read_b128 v[128:131], v40 offset:0
    ds_read_b128 v[144:147], v40 offset:4608
    ds_read_b128 v[132:135], v40 offset:64
    ds_read_b128 v[148:151], v40 offset:4672
    ds_read_b128 v[136:139], v40 offset:128
    ds_read_b128 v[152:155], v40 offset:4736
    ds_read_b128 v[140:143], v40 offset:192
    ds_read_b128 v[156:159], v40 offset:4800
    ds_write_addtid_b32 v104 offset:60608
    v_pk_mul_f16 v105, v104, v60 op_sel:[0,0] op_sel_hi:[1,0]
    v_pk_mul_f16 v106, v104, v61 op_sel:[0,0] op_sel_hi:[1,0]
    v_pk_fma_f16 v105, v104, v60, v105 op_sel:[1,1,0] op_sel_hi:[0,1,1] neg_hi:[1,0,0]
    v_pk_fma_f16 v106, v104, v61, v106 op_sel:[1,1,0] op_sel_hi:[0,1,1] neg_hi:[1,0,0]
    ds_write_addtid_b32 v105 offset:61472
    ds_write_addtid_b32 v106 offset:60032
    v_pk_mul_f16 v108, v104, v62 op_sel:[0,0] op_sel_hi:[1,0]
    v_pk_mul_f16 v112, v104, v68 op_sel:[0,0] op_sel_hi:[1,0]
    v_pk_fma_f16 v108, v104, v62, v108 op_sel:[1,1,0] op_sel_hi:[0,1,1] neg_hi:[1,0,0]
    v_pk_fma_f16 v112, v104, v68, v112 op_sel:[1,1,0] op_sel_hi:[0,1,1] neg_hi:[1,0,0]
    ds_write_addtid_b32 v108 offset:61760
    ds_write_addtid_b32 v112 offset:58880
    v_pk_mul_f16 v117, v104, v69 op_sel:[0,0] op_sel_hi:[1,0]
    v_pk_mul_f16 v123, v104, v70 op_sel:[0,0] op_sel_hi:[1,0]
    v_pk_fma_f16 v117, v104, v69, v117 op_sel:[1,1,0] op_sel_hi:[0,1,1] neg_hi:[1,0,0]
    v_pk_fma_f16 v123, v104, v70, v123 op_sel:[1,1,0] op_sel_hi:[0,1,1] neg_hi:[1,0,0]
    ds_write_addtid_b32 v117 offset:65504
    ds_write_addtid_b32 v123 offset:63488
    v_pk_mul_f16 v107, v106, v60 op_sel:[0,0] op_sel_hi:[1,0]
    v_pk_mul_f16 v109, v108, v60 op_sel:[0,0] op_sel_hi:[1,0]
    v_pk_fma_f16 v107, v106, v60, v107 op_sel:[1,1,0] op_sel_hi:[0,1,1] neg_hi:[1,0,0]
    v_pk_fma_f16 v109, v108, v60, v109 op_sel:[1,1,0] op_sel_hi:[0,1,1] neg_hi:[1,0,0]
    ds_write_addtid_b32 v107 offset:61184
    ds_write_addtid_b32 v109 offset:60320
    v_pk_mul_f16 v110, v108, v61 op_sel:[0,0] op_sel_hi:[1,0]
    v_pk_mul_f16 v113, v106, v68 op_sel:[0,0] op_sel_hi:[1,0]
    v_pk_fma_f16 v110, v108, v61, v110 op_sel:[1,1,0] op_sel_hi:[0,1,1] neg_hi:[1,0,0]
    v_pk_fma_f16 v113, v106, v68, v113 op_sel:[1,1,0] op_sel_hi:[0,1,1] neg_hi:[1,0,0]
    ds_write_addtid_b32 v110 offset:59168
    ds_write_addtid_b32 v113 offset:62336
    v_pk_mul_f16 v114, v108, v68 op_sel:[0,0] op_sel_hi:[1,0]
    v_pk_mul_f16 v118, v108, v69 op_sel:[0,0] op_sel_hi:[1,0]
    v_pk_fma_f16 v114, v108, v68, v114 op_sel:[1,1,0] op_sel_hi:[0,1,1] neg_hi:[1,0,0]
    v_pk_fma_f16 v118, v108, v69, v118 op_sel:[1,1,0] op_sel_hi:[0,1,1] neg_hi:[1,0,0]
    ds_write_addtid_b32 v114 offset:60896
    ds_write_addtid_b32 v118 offset:64640
    v_pk_mul_f16 v120, v112, v69 op_sel:[0,0] op_sel_hi:[1,0]
    v_pk_mul_f16 v124, v112, v70 op_sel:[0,0] op_sel_hi:[1,0]
    v_pk_fma_f16 v120, v112, v69, v120 op_sel:[1,1,0] op_sel_hi:[0,1,1] neg_hi:[1,0,0]
    v_pk_fma_f16 v124, v112, v70, v124 op_sel:[1,1,0] op_sel_hi:[0,1,1] neg_hi:[1,0,0]
    ds_write_addtid_b32 v120 offset:65216
    ds_write_addtid_b32 v124 offset:64064
    v_pk_mul_f16 v125, v117, v70 op_sel:[0,0] op_sel_hi:[1,0]
    v_pk_mul_f16 v127, v123, v70 op_sel:[0,0] op_sel_hi:[1,0]
    v_pk_fma_f16 v125, v117, v70, v125 op_sel:[1,1,0] op_sel_hi:[0,1,1] neg_hi:[1,0,0]
    v_pk_fma_f16 v127, v123, v70, v127 op_sel:[1,1,0] op_sel_hi:[0,1,1] neg_hi:[1,0,0]
    ds_write_addtid_b32 v125 offset:63200
    ds_write_addtid_b32 v127 offset:62912
    v_pk_mul_f16 v116, v112, v63 op_sel:[0,0] op_sel_hi:[1,0]
    v_pk_mul_f16 v119, v117, v63 op_sel:[0,0] op_sel_hi:[1,0]
    v_pk_fma_f16 v116, v112, v63, v116 op_sel:[1,1,0] op_sel_hi:[0,1,1] neg_hi:[1,0,0]
    v_pk_fma_f16 v119, v117, v63, v119 op_sel:[1,1,0] op_sel_hi:[0,1,1] neg_hi:[1,0,0]
    ds_write_addtid_b32 v116 offset:59456
    ds_write_addtid_b32 v119 offset:62624
    v_pk_mul_f16 v111, v110, v60 op_sel:[0,0] op_sel_hi:[1,0]
    v_pk_mul_f16 v115, v110, v68 op_sel:[0,0] op_sel_hi:[1,0]
    v_pk_fma_f16 v111, v110, v60, v111 op_sel:[1,1,0] op_sel_hi:[0,1,1] neg_hi:[1,0,0]
    v_pk_fma_f16 v115, v110, v68, v115 op_sel:[1,1,0] op_sel_hi:[0,1,1] neg_hi:[1,0,0]
    ds_write_addtid_b32 v111 offset:59744
    ds_write_addtid_b32 v115 offset:62048
    v_pk_mul_f16 v121, v114, v69 op_sel:[0,0] op_sel_hi:[1,0]
    v_pk_mul_f16 v126, v120, v70 op_sel:[0,0] op_sel_hi:[1,0]
    v_pk_fma_f16 v121, v114, v69, v121 op_sel:[1,1,0] op_sel_hi:[0,1,1] neg_hi:[1,0,0]
    v_pk_fma_f16 v126, v120, v70, v126 op_sel:[1,1,0] op_sel_hi:[0,1,1] neg_hi:[1,0,0]
    ds_write_addtid_b32 v121 offset:64352
    ds_write_addtid_b32 v126 offset:63776
    v_pk_mul_f16 v122, v120, v63 op_sel:[0,0] op_sel_hi:[1,0]
    v_pk_fma_f16 v122, v120, v63, v122 op_sel:[1,1,0] op_sel_hi:[0,1,1] neg_hi:[1,0,0]
    ds_write_addtid_b32 v122 offset:64928
    ds_read_b128 v[160:163], v41 offset:0
    ds_read_b128 v[164:167], v41 offset:64
    ds_read_b128 v[168:171], v41 offset:128
    ds_read_b128 v[172:175], v41 offset:192
    ds_read_b128 v[192:195], v42 offset:0
    ds_read_b128 v[196:199], v42 offset:64
    ds_read_b128 v[200:203], v42 offset:128
    ds_read_b128 v[204:207], v42 offset:192
    s_waitcnt lgkmcnt(15)
    s_barrier
    ds_read_b128 v[96:99], v41 offset:27648
    ds_read_b128 v[64:67], v40 offset:36864
    ds_read_b128 v[100:103], v41 offset:27712
    ds_read_b128 v[68:71], v40 offset:36928
    ds_read_b128 v[104:107], v41 offset:27776
    ds_read_b128 v[72:75], v40 offset:36992
    s_setprio 2
    s_waitcnt lgkmcnt(13)
    v_mfma_f32_16x16x32_f16 v[176:179], v[160:163], v[128:131], 0
    ds_read_b128 v[108:111], v41 offset:27840
    v_mfma_f32_16x16x32_f16 v[180:183], v[160:163], v[144:147], 0
    ds_read_b128 v[76:79], v40 offset:37056
    s_waitcnt lgkmcnt(12)
    v_mfma_f32_16x16x32_f16 v[176:179], v[164:167], v[132:135], v[176:179]
    ds_read_b128 v[80:83], v40 offset:41472
    v_mfma_f32_16x16x32_f16 v[180:183], v[164:167], v[148:151], v[180:183]
    ds_read_b128 v[84:87], v40 offset:41536
    v_mfma_f32_16x16x32_f16 v[176:179], v[168:171], v[136:139], v[176:179]
    ds_read_b128 v[88:91], v40 offset:41600
    v_mfma_f32_16x16x32_f16 v[180:183], v[168:171], v[152:155], v[180:183]
    ds_read_b128 v[92:95], v40 offset:41664
    v_mfma_f32_16x16x32_f16 v[176:179], v[172:175], v[140:143], v[176:179]
    ds_read_b128 v[112:115], v42 offset:27648
    v_mfma_f32_16x16x32_f16 v[180:183], v[172:175], v[156:159], v[180:183]
    ds_read_b128 v[116:119], v42 offset:27712
    s_waitcnt lgkmcnt(14)
    v_mfma_f32_16x16x32_f16 v[184:187], v[192:195], v[128:131], 0
    ds_read_b128 v[120:123], v42 offset:27776
    v_mfma_f32_16x16x32_f16 v[188:191], v[192:195], v[144:147], 0
    ds_read_b128 v[124:127], v42 offset:27840
    v_mfma_f32_16x16x32_f16 v[184:187], v[196:199], v[132:135], v[184:187]
    ds_read_b64 v[0:1], v23 offset:0
    v_mfma_f32_16x16x32_f16 v[188:191], v[196:199], v[148:151], v[188:191]
    ds_read_b64 v[2:3], v23 offset:8
    v_mfma_f32_16x16x32_f16 v[184:187], v[200:203], v[136:139], v[184:187]
    ds_read_b64 v[4:5], v23 offset:1216
    v_mfma_f32_16x16x32_f16 v[188:191], v[200:203], v[152:155], v[188:191]
    ds_read_b64 v[6:7], v23 offset:1224
    v_mfma_f32_16x16x32_f16 v[184:187], v[204:207], v[140:143], v[184:187]
    ds_read_b64 v[8:9], v23 offset:64
    v_mfma_f32_16x16x32_f16 v[188:191], v[204:207], v[156:159], v[188:191]
    ds_read_b64 v[10:11], v23 offset:72
    s_waitcnt lgkmcnt(14)
    v_mfma_f32_16x16x32_f16 v[176:179], v[96:99], v[64:67], v[176:179]
    ds_read_b64 v[12:13], v23 offset:1280
    v_mfma_f32_16x16x32_f16 v[176:179], v[100:103], v[68:71], v[176:179]
    ds_read_b64 v[14:15], v23 offset:1288
    v_mfma_f32_16x16x32_f16 v[176:179], v[104:107], v[72:75], v[176:179]
    ds_read_b64 v[32:33], v23 offset:128
    v_mfma_f32_16x16x32_f16 v[176:179], v[108:111], v[76:79], v[176:179]
    ds_read_b64 v[34:35], v23 offset:136
    s_waitcnt lgkmcnt(10)
    v_mfma_f32_16x16x32_f16 v[180:183], v[96:99], v[80:83], v[180:183]
    ds_write_b64 v27, v[18:19]
    v_mfma_f32_16x16x32_f16 v[180:183], v[100:103], v[84:87], v[180:183]
    ds_write_b8 v26, v29 offset:64
    s_nop 0
    v_mfma_f32_16x16x32_f16 v[180:183], v[104:107], v[88:91], v[180:183]
    v_fma_f32 v176, v176, v16, v17
    v_mul_f32 v177, v177, v16
    v_mfma_f32_16x16x32_f16 v[180:183], v[108:111], v[92:95], v[180:183]
    v_mul_f32 v178, v178, v16
    v_mul_f32 v179, v179, v16
    v_mfma_f32_16x16x32_f16 v[184:187], v[112:115], v[64:67], v[184:187]
    v_cvt_pk_bf16_f32 v240, v176, v177
    v_cvt_pk_bf16_f32 v241, v178, v179
    v_mfma_f32_16x16x32_f16 v[188:191], v[112:115], v[80:83], v[188:191]
    ds_write_b64 v24, v[240:241] offset:32
    v_mfma_f32_16x16x32_f16 v[184:187], v[116:119], v[68:71], v[184:187]
    ds_read_b64_tr_b16 v[192:193], v22 offset:32
    s_nop 0
    v_mfma_f32_16x16x32_f16 v[188:191], v[116:119], v[84:87], v[188:191]
    ds_read_b64_tr_b16 v[194:195], v22 offset:0
    v_mul_f32 v180, v180, v16
    v_mfma_f32_16x16x32_f16 v[184:187], v[120:123], v[72:75], v[184:187]
    ds_read_b64 v[36:37], v23 offset:1344
    v_mul_f32 v181, v181, v16
    v_mfma_f32_16x16x32_f16 v[188:191], v[120:123], v[88:91], v[188:191]
    v_mul_f32 v182, v182, v16
    v_mul_f32 v183, v183, v16
    v_mfma_f32_16x16x32_f16 v[184:187], v[124:127], v[76:79], v[184:187]
    v_cvt_pk_bf16_f32 v242, v180, v181
    v_cvt_pk_bf16_f32 v243, v182, v183
    v_mfma_f32_16x16x32_f16 v[188:191], v[124:127], v[92:95], v[188:191]
    ds_write_b64 v24, v[242:243] offset:288
    ds_read_b64_tr_b16 v[196:197], v22 offset:288
    ds_read_b64_tr_b16 v[198:199], v22 offset:256
    s_setprio 0
    s_cmp_eq_u32 0, 1
    s_waitcnt lgkmcnt(4)
    v_mfma_f32_16x16x32_bf16 v[40:43], v[192:195], v[0:3], 0
    ds_read_b64 v[38:39], v23 offset:1352
    s_nop 0
    v_mfma_f32_16x16x32_bf16 v[44:47], v[192:195], v[4:7], 0
    ds_read_b64 v[48:49], v23 offset:192
    s_nop 0
    v_mfma_f32_16x16x32_bf16 v[52:55], v[192:195], v[8:11], 0
    ds_read_b64 v[50:51], v23 offset:200
    v_mul_f32 v186, v186, v16
    v_mfma_f32_16x16x32_bf16 v[56:59], v[192:195], v[12:15], 0
    ds_read_b64 v[60:61], v23 offset:1408
    s_waitcnt lgkmcnt(4)
    v_mfma_f32_16x16x32_bf16 v[52:55], v[196:199], v[0:3], v[52:55]
    ds_read_b64 v[62:63], v23 offset:1416
    v_mul_f32 v184, v184, v16
    v_mfma_f32_16x16x32_bf16 v[56:59], v[196:199], v[4:7], v[56:59]
    ds_read_b64_tr_b16 v[200:201], v22 offset:544
    v_mul_f32 v185, v185, v16
    v_mfma_f32_16x16x32_bf16 v[128:131], v[196:199], v[8:11], 0
    ds_read_b64_tr_b16 v[202:203], v22 offset:512
    v_mul_f32 v188, v188, v16
    v_mfma_f32_16x16x32_bf16 v[132:135], v[196:199], v[12:15], 0
    ds_read_b64_tr_b16 v[204:205], v22 offset:800
    v_mov_b32_dpp v244, v186 quad_perm:[0,0,2,2] row_mask:0xf bank_mask:0xf
    v_mfma_f32_16x16x32_bf16 v[128:131], v[192:195], v[32:35], v[128:131]
    ds_read_b64_tr_b16 v[206:207], v22 offset:768
    s_waitcnt lgkmcnt(8)
    v_mfma_f32_16x16x32_bf16 v[132:135], v[192:195], v[36:39], v[132:135]
    v_cvt_pk_bf16_f32 v245, v186, v186
    v_mul_f32 v189, v189, v16
    v_mfma_f32_16x16x32_bf16 v[136:139], v[196:199], v[32:35], 0
    v_cvt_pk_bf16_f32 v244, v244, v186
    v_mfma_f32_16x16x32_bf16 v[140:143], v[196:199], v[36:39], 0
    s_waitcnt lgkmcnt(5)
    v_mfma_f32_16x16x32_bf16 v[136:139], v[192:195], v[48:51], v[136:139]
    s_waitcnt lgkmcnt(4)
    v_mfma_f32_16x16x32_bf16 v[140:143], v[192:195], v[60:63], v[140:143]
    ds_write_b64 v20, v[244:245]
    v_mfma_f32_16x16x32_bf16 v[144:147], v[196:199], v[48:51], 0
    v_cvt_pk_bf16_f32 v247, v184, v185
    v_cvt_pk_bf16_f32 v246, v184, v184
    v_mfma_f32_16x16x32_bf16 v[148:151], v[196:199], v[60:63], 0
    v_cvt_pk_bf16_f32 v249, v188, v189
    s_waitcnt lgkmcnt(2)
    v_mfma_f32_16x16x32_bf16 v[128:131], v[200:203], v[0:3], v[128:131]
    v_perm_b32 v247, v247, v247, v25
    v_mfma_f32_16x16x32_bf16 v[132:135], v[200:203], v[4:7], v[132:135]
    ds_write_b64 v24, v[246:247] offset:1056
    v_mfma_f32_16x16x32_bf16 v[136:139], v[200:203], v[8:11], v[136:139]
    v_cvt_pk_bf16_f32 v248, v188, v188
    v_perm_b32 v249, v249, v249, v25
    v_mfma_f32_16x16x32_bf16 v[140:143], v[200:203], v[12:15], v[140:143]
    s_waitcnt lgkmcnt(2)
    v_mfma_f32_16x16x32_bf16 v[136:139], v[204:207], v[0:3], v[136:139]
    ds_read_b64 v[18:19], v30
    v_mfma_f32_16x16x32_bf16 v[140:143], v[204:207], v[4:7], v[140:143]
    ds_write_b64 v24, v[248:249] offset:1312
    v_mfma_f32_16x16x32_bf16 v[144:147], v[200:203], v[32:35], v[144:147]
    ds_read_b64_tr_b16 v[208:209], v22 offset:1056
    v_mfma_f32_16x16x32_bf16 v[148:151], v[200:203], v[36:39], v[148:151]
    ds_read_b64_tr_b16 v[210:211], v22 offset:1024
    v_mfma_f32_16x16x32_bf16 v[144:147], v[204:207], v[8:11], v[144:147]
    ds_read_b64_tr_b16 v[212:213], v22 offset:1312
    v_mfma_f32_16x16x32_bf16 v[148:151], v[204:207], v[12:15], v[148:151]
    ds_read_b64_tr_b16 v[214:215], v22 offset:1280
    v_mfma_f32_16x16x32_bf16 v[152:155], v[200:203], v[48:51], 0
    ds_read_b64_tr_b16 v[216:217], v22 offset:1568
    v_mfma_f32_16x16x32_bf16 v[156:159], v[200:203], v[60:63], 0
    ds_read_b64_tr_b16 v[218:219], v22 offset:1536
    v_mfma_f32_16x16x32_bf16 v[152:155], v[204:207], v[32:35], v[152:155]
    s_waitcnt lgkmcnt(7)
    v_cmp_ne_u64 vcc, s[54:55], v[18:19]
    v_mfma_f32_16x16x32_bf16 v[156:159], v[204:207], v[36:39], v[156:159]
    ds_read_b64_tr_b16 v[220:221], v22 offset:1824
    v_mfma_f32_16x16x32_bf16 v[160:163], v[204:207], v[48:51], 0
    s_cbranch_vccnz L_gate_slow0
L_gate_ok0:
    v_mfma_f32_16x16x32_bf16 v[164:167], v[204:207], v[60:63], 0
    ds_read_b64_tr_b16 v[222:223], v22 offset:1792
    s_waitcnt lgkmcnt(6)
    v_mfma_f32_16x16x32_bf16 v[144:147], v[208:211], v[0:3], v[144:147]
    ds_write_b32 v28, v31
    v_mfma_f32_16x16x32_bf16 v[148:151], v[208:211], v[4:7], v[148:151]
    ds_read_b64 v[168:169], v23 offset:256
    v_add_f32 v42, v42, v45
    v_mfma_f32_16x16x32_bf16 v[152:155], v[208:211], v[8:11], v[152:155]
    ds_read_b64 v[170:171], v23 offset:264
    v_add_f32 v41, v41, v44
    v_mfma_f32_16x16x32_bf16 v[156:159], v[208:211], v[12:15], v[156:159]
    ds_read_b64 v[172:173], v23 offset:1472
    s_waitcnt lgkmcnt(6)
    v_mfma_f32_16x16x32_bf16 v[152:155], v[212:215], v[0:3], v[152:155]
    ds_read_b64 v[174:175], v23 offset:1480
    v_add_f32 v43, v43, v46
    v_mfma_f32_16x16x32_bf16 v[156:159], v[212:215], v[4:7], v[156:159]
    ds_read_b64 v[64:65], v23 offset:320
    v_add_f32_dpp v42, v40, v42 row_ror:8 row_mask:0xf bank_mask:0x3
    v_mfma_f32_16x16x32_bf16 v[160:163], v[208:211], v[32:35], v[160:163]
    ds_read_b64 v[66:67], v23 offset:328
    v_add_f32_dpp v43, v41, v43 row_ror:8 row_mask:0xf bank_mask:0x3
    v_mfma_f32_16x16x32_bf16 v[164:167], v[208:211], v[36:39], v[164:167]
    ds_read_b64 v[68:69], v23 offset:1536
    v_add_f32_dpp v40, v47, v42 row_ror:8 row_mask:0xf bank_mask:0xc
    v_mfma_f32_16x16x32_bf16 v[160:163], v[212:215], v[8:11], v[160:163]
    ds_write_b32 v21, v43 offset:3264
    v_mfma_f32_16x16x32_bf16 v[164:167], v[212:215], v[12:15], v[164:167]
    ds_read_b64 v[70:71], v23 offset:1544
    v_mov_b32_dpp v41, v43 quad_perm:[0,1,2,3] row_mask:0xf bank_mask:0xc
    v_mfma_f32_16x16x32_bf16 v[160:163], v[216:219], v[0:3], v[160:163]
    ds_read_b64 v[72:73], v23 offset:384
    v_mov_b32_dpp v42, v47 quad_perm:[0,1,2,3] row_mask:0xf bank_mask:0xc
    v_mfma_f32_16x16x32_bf16 v[164:167], v[216:219], v[4:7], v[164:167]
    ds_write_b32 v21, v40 offset:0
    v_mfma_f32_16x16x32_bf16 v[76:79], v[208:211], v[48:51], 0
    ds_write_b32 v21, v41 offset:1088
    v_mfma_f32_16x16x32_bf16 v[80:83], v[208:211], v[60:63], 0
    ds_write_b32 v21, v42 offset:2176
    v_mfma_f32_16x16x32_bf16 v[76:79], v[212:215], v[32:35], v[76:79]
    ds_write_b8 v26, v29 offset:0
    v_mfma_f32_16x16x32_bf16 v[80:83], v[212:215], v[36:39], v[80:83]
    ds_read_b64 v[74:75], v23 offset:392
    v_add_f32 v54, v54, v57
    v_mfma_f32_16x16x32_bf16 v[76:79], v[216:219], v[8:11], v[76:79]
    ds_read_b64 v[84:85], v23 offset:1600
    v_add_f32 v53, v53, v56
    v_mfma_f32_16x16x32_bf16 v[80:83], v[216:219], v[12:15], v[80:83]
    ds_read_b64 v[86:87], v23 offset:1608
    s_waitcnt lgkmcnt(8)
    v_mfma_f32_16x16x32_bf16 v[76:79], v[220:223], v[0:3], v[76:79]
    ds_read_b64 v[88:89], v23 offset:448
    v_add_f32 v55, v55, v58
    v_mfma_f32_16x16x32_bf16 v[80:83], v[220:223], v[4:7], v[80:83]
    ds_read_b64 v[90:91], v23 offset:456
    v_add_f32_dpp v54, v52, v54 row_ror:8 row_mask:0xf bank_mask:0x3
    v_mfma_f32_16x16x32_bf16 v[92:95], v[212:215], v[48:51], 0
    ds_read_b64 v[96:97], v23 offset:1664
    v_add_f32_dpp v55, v53, v55 row_ror:8 row_mask:0xf bank_mask:0x3
    v_mfma_f32_16x16x32_bf16 v[100:103], v[212:215], v[60:63], 0
    ds_read_b64 v[98:99], v23 offset:1672
L_hop:
    s_cbranch_scc1 L_hop_back
    v_mfma_f32_16x16x32_bf16 v[92:95], v[216:219], v[32:35], v[92:95]
    v_add_f32_dpp v52, v59, v54 row_ror:8 row_mask:0xf bank_mask:0xc
    v_mfma_f32_16x16x32_bf16 v[100:103], v[216:219], v[36:39], v[100:103]
    ds_write_b32 v21, v55 offset:7552
    v_mfma_f32_16x16x32_bf16 v[92:95], v[220:223], v[8:11], v[92:95]
    v_mov_b32_dpp v53, v55 quad_perm:[0,1,2,3] row_mask:0xf bank_mask:0xc
    v_mov_b32_dpp v54, v59 quad_perm:[0,1,2,3] row_mask:0xf bank_mask:0xc
    v_mfma_f32_16x16x32_bf16 v[100:103], v[220:223], v[12:15], v[100:103]
    ds_write_b32 v21, v52 offset:4288
    v_mfma_f32_16x16x32_bf16 v[104:107], v[216:219], v[48:51], 0
    ds_write_b32 v21, v53 offset:5376
    v_mfma_f32_16x16x32_bf16 v[108:111], v[216:219], v[60:63], 0
    ds_write_b32 v21, v54 offset:6464
    v_mfma_f32_16x16x32_bf16 v[104:107], v[220:223], v[32:35], v[104:107]
    ds_write_b8 v26, v29 offset:4
    v_mfma_f32_16x16x32_bf16 v[108:111], v[220:223], v[36:39], v[108:111]
    v_mul_f32 v190, v190, v16
    v_mul_f32 v187, v187, v16
    v_mfma_f32_16x16x32_bf16 v[112:115], v[220:223], v[48:51], 0
    ds_write2_b32 v20, v245, v245 offset0:2 offset1:3
    v_mfma_f32_16x16x32_bf16 v[116:119], v[220:223], v[60:63], 0
    v_mov_b32_dpp v250, v190 quad_perm:[0,0,2,2] row_mask:0xf bank_mask:0xf
    v_cvt_pk_bf16_f32 v251, v190, v190
    v_mfma_f32_16x16x32_bf16 v[144:147], v[192:195], v[168:171], v[144:147]
    ds_write2_b32 v20, v251, v251 offset0:66 offset1:67
    v_mfma_f32_16x16x32_bf16 v[148:151], v[192:195], v[172:175], v[148:151]
    v_cvt_pk_bf16_f32 v250, v250, v190
    v_cvt_pk_bf16_f32 v252, v187, v187
    v_mfma_f32_16x16x32_bf16 v[152:155], v[196:199], v[168:171], v[152:155]
    ds_write_b64 v20, v[250:251] offset:256
    v_mfma_f32_16x16x32_bf16 v[156:159], v[196:199], v[172:175], v[156:159]
    v_cvt_pk_bf16_f32 v253, v187, v187
    v_mfma_f32_16x16x32_bf16 v[152:155], v[192:195], v[64:67], v[152:155]
    ds_write_b64 v20, v[252:253] offset:2048
    v_mfma_f32_16x16x32_bf16 v[156:159], v[192:195], v[68:71], v[156:159]
    ds_read_b64_tr_b16 v[224:225], v22 offset:2080
    v_add_f32 v130, v130, v133
    v_mfma_f32_16x16x32_bf16 v[160:163], v[200:203], v[168:171], v[160:163]
    ds_read_b64_tr_b16 v[226:227], v22 offset:2048
    v_add_f32 v129, v129, v132
    v_mfma_f32_16x16x32_bf16 v[164:167], v[200:203], v[172:175], v[164:167]
    ds_read_b64_tr_b16 v[228:229], v22 offset:2336
    v_add_f32 v131, v131, v134
    v_mfma_f32_16x16x32_bf16 v[160:163], v[196:199], v[64:67], v[160:163]
    ds_read_b64_tr_b16 v[230:231], v22 offset:2304
    v_add_f32_dpp v130, v128, v130 row_ror:8 row_mask:0xf bank_mask:0x3
    v_mfma_f32_16x16x32_bf16 v[164:167], v[196:199], v[68:71], v[164:167]
    ds_read_b64_tr_b16 v[232:233], v22 offset:2592
    s_waitcnt lgkmcnt(7)
    v_mfma_f32_16x16x32_bf16 v[160:163], v[192:195], v[72:75], v[160:163]
    ds_read_b64_tr_b16 v[234:235], v22 offset:2560
    v_add_f32_dpp v131, v129, v131 row_ror:8 row_mask:0xf bank_mask:0x3
    v_mfma_f32_16x16x32_bf16 v[164:167], v[192:195], v[84:87], v[164:167]
    ds_read_b64_tr_b16 v[236:237], v22 offset:2848
    v_add_f32_dpp v128, v135, v130 row_ror:8 row_mask:0xf bank_mask:0xc
    v_mfma_f32_16x16x32_bf16 v[76:79], v[204:207], v[168:171], v[76:79]
    ds_write_b32 v21, v131 offset:11840
    v_mfma_f32_16x16x32_bf16 v[80:83], v[204:207], v[172:175], v[80:83]
    ds_read_b64_tr_b16 v[238:239], v22 offset:2816
    v_mov_b32_dpp v129, v131 quad_perm:[0,1,2,3] row_mask:0xf bank_mask:0xc
    v_mfma_f32_16x16x32_bf16 v[76:79], v[200:203], v[64:67], v[76:79]
    ds_read_b64_tr_b16 v[240:241], v22 offset:3104
    v_mov_b32_dpp v130, v135 quad_perm:[0,1,2,3] row_mask:0xf bank_mask:0xc
    v_mfma_f32_16x16x32_bf16 v[80:83], v[200:203], v[68:71], v[80:83]
    ds_write_b32 v21, v128 offset:8576
    v_mfma_f32_16x16x32_bf16 v[76:79], v[196:199], v[72:75], v[76:79]
    ds_write_b32 v21, v129 offset:9664
    v_mfma_f32_16x16x32_bf16 v[80:83], v[196:199], v[84:87], v[80:83]
    ds_write_b32 v21, v130 offset:10752
    v_mfma_f32_16x16x32_bf16 v[76:79], v[192:195], v[88:91], v[76:79]
    ds_write_b8 v26, v29 offset:8
    v_mfma_f32_16x16x32_bf16 v[80:83], v[192:195], v[96:99], v[80:83]
    ds_read_b64_tr_b16 v[242:243], v22 offset:3072
    v_add_f32 v138, v138, v141
    v_mfma_f32_16x16x32_bf16 v[92:95], v[196:199], v[88:91], v[92:95]
    ds_read_b64_tr_b16 v[244:245], v22 offset:3360
    v_add_f32 v137, v137, v140
    v_mfma_f32_16x16x32_bf16 v[100:103], v[196:199], v[96:99], v[100:103]
    ds_read_b64_tr_b16 v[246:247], v22 offset:3328
    v_add_f32 v139, v139, v142
    v_mfma_f32_16x16x32_bf16 v[92:95], v[200:203], v[72:75], v[92:95]
    ds_read_b64_tr_b16 v[248:249], v22 offset:3616
    v_add_f32_dpp v138, v136, v138 row_ror:8 row_mask:0xf bank_mask:0x3
    v_mfma_f32_16x16x32_bf16 v[100:103], v[200:203], v[84:87], v[100:103]
    ds_read_b64_tr_b16 v[250:251], v22 offset:3584
    v_add_f32_dpp v139, v137, v139 row_ror:8 row_mask:0xf bank_mask:0x3
    v_mfma_f32_16x16x32_bf16 v[92:95], v[204:207], v[64:67], v[92:95]
    ds_read_b64_tr_b16 v[252:253], v22 offset:3872
    v_add_f32_dpp v136, v143, v138 row_ror:8 row_mask:0xf bank_mask:0xc
    v_mfma_f32_16x16x32_bf16 v[100:103], v[204:207], v[68:71], v[100:103]
    ds_write_b32 v21, v139 offset:16128
    v_mfma_f32_16x16x32_bf16 v[92:95], v[208:211], v[168:171], v[92:95]
    ds_read_b64_tr_b16 v[254:255], v22 offset:3840
    v_mov_b32_dpp v137, v139 quad_perm:[0,1,2,3] row_mask:0xf bank_mask:0xc
    v_mfma_f32_16x16x32_bf16 v[100:103], v[208:211], v[172:175], v[100:103]
    v_mov_b32_dpp v138, v143 quad_perm:[0,1,2,3] row_mask:0xf bank_mask:0xc
    s_waitcnt lgkmcnt(7)
    v_mfma_f32_16x16x32_bf16 v[92:95], v[224:227], v[0:3], v[92:95]
    ds_write_b32 v21, v136 offset:12864
    v_mfma_f32_16x16x32_bf16 v[100:103], v[224:227], v[4:7], v[100:103]
    ds_write_b32 v21, v137 offset:13952
    v_mfma_f32_16x16x32_bf16 v[104:107], v[200:203], v[88:91], v[104:107]
    ds_write_b32 v21, v138 offset:15040
    v_mfma_f32_16x16x32_bf16 v[108:111], v[200:203], v[96:99], v[108:111]
    ds_read_b32 v18, v30 offset:8
    v_mfma_f32_16x16x32_bf16 v[104:107], v[204:207], v[72:75], v[104:107]
    ds_write_b8 v26, v29 offset:12
    v_mfma_f32_16x16x32_bf16 v[108:111], v[204:207], v[84:87], v[108:111]
    v_add_f32 v146, v146, v149
    v_add_f32 v145, v145, v148
    v_mfma_f32_16x16x32_bf16 v[104:107], v[208:211], v[64:67], v[104:107]
    v_add_f32 v147, v147, v150
    v_add_f32_dpp v146, v144, v146 row_ror:8 row_mask:0xf bank_mask:0x3
    v_mfma_f32_16x16x32_bf16 v[108:111], v[208:211], v[68:71], v[108:111]
    v_add_f32_dpp v147, v145, v147 row_ror:8 row_mask:0xf bank_mask:0x3
    v_add_f32_dpp v144, v151, v146 row_ror:8 row_mask:0xf bank_mask:0xc
    v_mfma_f32_16x16x32_bf16 v[104:107], v[212:215], v[168:171], v[104:107]
    ds_write_b32 v21, v147 offset:20416
    v_mfma_f32_16x16x32_bf16 v[108:111], v[212:215], v[172:175], v[108:111]
    v_mov_b32_dpp v145, v147 quad_perm:[0,1,2,3] row_mask:0xf bank_mask:0xc
    v_mov_b32_dpp v146, v151 quad_perm:[0,1,2,3] row_mask:0xf bank_mask:0xc
    v_mfma_f32_16x16x32_bf16 v[104:107], v[224:227], v[8:11], v[104:107]
    ds_write_b32 v21, v144 offset:17152
    v_mfma_f32_16x16x32_bf16 v[108:111], v[224:227], v[12:15], v[108:111]
    s_waitcnt lgkmcnt(3)
    v_cmp_ne_u32 vcc, s54, v18
    v_mfma_f32_16x16x32_bf16 v[104:107], v[228:231], v[0:3], v[104:107]
    ds_write_b32 v21, v145 offset:18240
    v_mfma_f32_16x16x32_bf16 v[108:111], v[228:231], v[4:7], v[108:111]
    s_cbranch_vccnz L_gate_slow1
L_gate_ok1:
    v_mfma_f32_16x16x32_bf16 v[112:115], v[204:207], v[88:91], v[112:115]
    ds_write_b32 v21, v146 offset:19328
    v_mfma_f32_16x16x32_bf16 v[116:119], v[204:207], v[96:99], v[116:119]
    ds_write_b8 v26, v29 offset:16
    v_mfma_f32_16x16x32_bf16 v[112:115], v[208:211], v[72:75], v[112:115]
    ds_read_b64 v[120:121], v23 offset:512
    v_add_f32 v154, v154, v157
    v_mfma_f32_16x16x32_bf16 v[116:119], v[208:211], v[84:87], v[116:119]
    ds_read_b64 v[122:123], v23 offset:520
    v_add_f32 v153, v153, v156
    v_mfma_f32_16x16x32_bf16 v[112:115], v[212:215], v[64:67], v[112:115]
    ds_read_b64 v[124:125], v23 offset:1728
    v_add_f32 v155, v155, v158
    v_mfma_f32_16x16x32_bf16 v[116:119], v[212:215], v[68:71], v[116:119]
    ds_read_b64 v[126:127], v23 offset:1736
    v_add_f32_dpp v154, v152, v154 row_ror:8 row_mask:0xf bank_mask:0x3
    v_mfma_f32_16x16x32_bf16 v[112:115], v[216:219], v[168:171], v[112:115]
    ds_read_b64 v[40:41], v23 offset:576
    v_add_f32_dpp v155, v153, v155 row_ror:8 row_mask:0xf bank_mask:0x3
    v_mfma_f32_16x16x32_bf16 v[116:119], v[216:219], v[172:175], v[116:119]
    ds_read_b64 v[42:43], v23 offset:584
    v_add_f32_dpp v152, v159, v154 row_ror:8 row_mask:0xf bank_mask:0xc
    v_mfma_f32_16x16x32_bf16 v[112:115], v[224:227], v[32:35], v[112:115]
    ds_write_b32 v21, v155 offset:24704
    v_mfma_f32_16x16x32_bf16 v[116:119], v[224:227], v[36:39], v[116:119]
    ds_read_b64 v[44:45], v23 offset:1792
    v_mov_b32_dpp v153, v155 quad_perm:[0,1,2,3] row_mask:0xf bank_mask:0xc
    v_mfma_f32_16x16x32_bf16 v[112:115], v[228:231], v[8:11], v[112:115]
    ds_read_b64 v[46:47], v23 offset:1800
    v_mov_b32_dpp v154, v159 quad_perm:[0,1,2,3] row_mask:0xf bank_mask:0xc
    v_mfma_f32_16x16x32_bf16 v[116:119], v[228:231], v[12:15], v[116:119]
    ds_write_b32 v21, v152 offset:21440
    v_mfma_f32_16x16x32_bf16 v[112:115], v[232:235], v[0:3], v[112:115]
    ds_write_b32 v21, v153 offset:22528
    v_mfma_f32_16x16x32_bf16 v[116:119], v[232:235], v[4:7], v[116:119]
    ds_write_b32 v21, v154 offset:23616
    v_mfma_f32_16x16x32_bf16 v[52:55], v[208:211], v[88:91], 0
    ds_write_b8 v26, v29 offset:20
    v_mfma_f32_16x16x32_bf16 v[56:59], v[208:211], v[96:99], 0
    ds_read_b64 v[176:177], v23 offset:640
    v_add_f32 v162, v162, v165
    v_mfma_f32_16x16x32_bf16 v[52:55], v[212:215], v[72:75], v[52:55]
    ds_read_b64 v[178:179], v23 offset:648
    v_add_f32 v161, v161, v164
    v_mfma_f32_16x16x32_bf16 v[56:59], v[212:215], v[84:87], v[56:59]
    ds_read_b64 v[180:181], v23 offset:1856
    v_add_f32 v163, v163, v166
    v_mfma_f32_16x16x32_bf16 v[52:55], v[216:219], v[64:67], v[52:55]
    ds_read_b64 v[182:183], v23 offset:1864
    v_add_f32_dpp v162, v160, v162 row_ror:8 row_mask:0xf bank_mask:0x3
    v_mfma_f32_16x16x32_bf16 v[56:59], v[216:219], v[68:71], v[56:59]
    ds_read_b64 v[184:185], v23 offset:704
    v_add_f32_dpp v163, v161, v163 row_ror:8 row_mask:0xf bank_mask:0x3
    v_mfma_f32_16x16x32_bf16 v[52:55], v[220:223], v[168:171], v[52:55]
    ds_read_b64 v[186:187], v23 offset:712
    v_add_f32_dpp v160, v167, v162 row_ror:8 row_mask:0xf bank_mask:0xc
    v_mfma_f32_16x16x32_bf16 v[56:59], v[220:223], v[172:175], v[56:59]
    ds_write_b32 v21, v163 offset:28992
    v_mfma_f32_16x16x32_bf16 v[52:55], v[224:227], v[48:51], v[52:55]
    ds_read_b64 v[188:189], v23 offset:1920
    v_mov_b32_dpp v161, v163 quad_perm:[0,1,2,3] row_mask:0xf bank_mask:0xc
    v_mfma_f32_16x16x32_bf16 v[56:59], v[224:227], v[60:63], v[56:59]
    ds_read_b64 v[190:191], v23 offset:1928
    v_mov_b32_dpp v162, v167 quad_perm:[0,1,2,3] row_mask:0xf bank_mask:0xc
    v_mfma_f32_16x16x32_bf16 v[52:55], v[228:231], v[32:35], v[52:55]
    ds_write_b32 v21, v160 offset:25728
    v_mfma_f32_16x16x32_bf16 v[56:59], v[228:231], v[36:39], v[56:59]
    ds_write_b32 v21, v161 offset:26816
    v_mfma_f32_16x16x32_bf16 v[52:55], v[232:235], v[8:11], v[52:55]
    ds_write_b32 v21, v162 offset:27904
    v_mfma_f32_16x16x32_bf16 v[56:59], v[232:235], v[12:15], v[56:59]
    ds_write_b8 v26, v29 offset:24
    v_mfma_f32_16x16x32_bf16 v[52:55], v[236:239], v[0:3], v[52:55]
    v_add_f32 v78, v78, v81
    v_add_f32 v77, v77, v80
    v_mfma_f32_16x16x32_bf16 v[56:59], v[236:239], v[4:7], v[56:59]
    v_add_f32 v79, v79, v82
    s_waitcnt lgkmcnt(6)
    v_mfma_f32_16x16x32_bf16 v[92:95], v[192:195], v[120:123], v[92:95]
    v_add_f32_dpp v78, v76, v78 row_ror:8 row_mask:0xf bank_mask:0x3
    v_add_f32_dpp v79, v77, v79 row_ror:8 row_mask:0xf bank_mask:0x3
    v_mfma_f32_16x16x32_bf16 v[100:103], v[192:195], v[124:127], v[100:103]
    v_add_f32_dpp v76, v83, v78 row_ror:8 row_mask:0xf bank_mask:0xc
    v_mfma_f32_16x16x32_bf16 v[104:107], v[196:199], v[120:123], v[104:107]
    ds_write_b32 v21, v79 offset:33280
    v_mfma_f32_16x16x32_bf16 v[108:111], v[196:199], v[124:127], v[108:111]
    v_mov_b32_dpp v77, v79 quad_perm:[0,1,2,3] row_mask:0xf bank_mask:0xc
    v_mov_b32_dpp v78, v83 quad_perm:[0,1,2,3] row_mask:0xf bank_mask:0xc
    v_mfma_f32_16x16x32_bf16 v[104:107], v[192:195], v[40:43], v[104:107]
    ds_write_b32 v21, v76 offset:30016
    v_mfma_f32_16x16x32_bf16 v[108:111], v[192:195], v[44:47], v[108:111]
    ds_write_b32 v21, v77 offset:31104
    v_mfma_f32_16x16x32_bf16 v[112:115], v[200:203], v[120:123], v[112:115]
    ds_write_b32 v21, v78 offset:32192
    v_mfma_f32_16x16x32_bf16 v[116:119], v[200:203], v[124:127], v[116:119]
    ds_write_b8 v26, v29 offset:28
    v_mfma_f32_16x16x32_bf16 v[112:115], v[196:199], v[40:43], v[112:115]
    v_add_f32 v94, v94, v101
    v_add_f32 v93, v93, v100
    v_mfma_f32_16x16x32_bf16 v[116:119], v[196:199], v[44:47], v[116:119]
    v_add_f32 v95, v95, v102
    v_add_f32_dpp v94, v92, v94 row_ror:8 row_mask:0xf bank_mask:0x3
    v_mfma_f32_16x16x32_bf16 v[112:115], v[192:195], v[176:179], v[112:115]
    v_add_f32_dpp v95, v93, v95 row_ror:8 row_mask:0xf bank_mask:0x3
    v_add_f32_dpp v92, v103, v94 row_ror:8 row_mask:0xf bank_mask:0xc
    v_mfma_f32_16x16x32_bf16 v[116:119], v[192:195], v[180:183], v[116:119]
    ds_write_b32 v21, v95 offset:37568
    v_mfma_f32_16x16x32_bf16 v[52:55], v[204:207], v[120:123], v[52:55]
    v_mov_b32_dpp v93, v95 quad_perm:[0,1,2,3] row_mask:0xf bank_mask:0xc
    v_mov_b32_dpp v94, v103 quad_perm:[0,1,2,3] row_mask:0xf bank_mask:0xc
    v_mfma_f32_16x16x32_bf16 v[56:59], v[204:207], v[124:127], v[56:59]
    ds_write_b32 v21, v92 offset:34304
    v_mfma_f32_16x16x32_bf16 v[52:55], v[200:203], v[40:43], v[52:55]
    ds_write_b32 v21, v93 offset:35392
    v_mfma_f32_16x16x32_bf16 v[56:59], v[200:203], v[44:47], v[56:59]
    ds_write_b32 v21, v94 offset:36480
    v_mfma_f32_16x16x32_bf16 v[52:55], v[196:199], v[176:179], v[52:55]
    ds_write_b8 v26, v29 offset:32
    v_mfma_f32_16x16x32_bf16 v[56:59], v[196:199], v[180:183], v[56:59]
    v_add_f32 v106, v106, v109
    v_add_f32 v105, v105, v108
    v_mfma_f32_16x16x32_bf16 v[52:55], v[192:195], v[184:187], v[52:55]
    v_add_f32 v107, v107, v110
    s_waitcnt lgkmcnt(5)
    v_mfma_f32_16x16x32_bf16 v[56:59], v[192:195], v[188:191], v[56:59]
    v_add_f32_dpp v106, v104, v106 row_ror:8 row_mask:0xf bank_mask:0x3
    v_add_f32_dpp v107, v105, v107 row_ror:8 row_mask:0xf bank_mask:0x3
    v_mfma_f32_16x16x32_bf16 v[128:131], v[240:243], v[0:3], 0
    ds_read_b32 v18, v30 offset:12
    v_add_f32_dpp v104, v111, v106 row_ror:8 row_mask:0xf bank_mask:0xc
    v_mfma_f32_16x16x32_bf16 v[132:135], v[240:243], v[4:7], 0
    ds_write_b32 v21, v107 offset:41856
    v_mfma_f32_16x16x32_bf16 v[128:131], v[236:239], v[8:11], v[128:131]
    v_mov_b32_dpp v105, v107 quad_perm:[0,1,2,3] row_mask:0xf bank_mask:0xc
    v_mov_b32_dpp v106, v111 quad_perm:[0,1,2,3] row_mask:0xf bank_mask:0xc
    v_mfma_f32_16x16x32_bf16 v[132:135], v[236:239], v[12:15], v[132:135]
    ds_write_b32 v21, v104 offset:38592
    v_mfma_f32_16x16x32_bf16 v[128:131], v[232:235], v[32:35], v[128:131]
    ds_write_b32 v21, v105 offset:39680
    v_mfma_f32_16x16x32_bf16 v[132:135], v[232:235], v[36:39], v[132:135]
    ds_write_b32 v21, v106 offset:40768
    v_mfma_f32_16x16x32_bf16 v[128:131], v[228:231], v[48:51], v[128:131]
    ds_write_b8 v26, v29 offset:36
    v_mfma_f32_16x16x32_bf16 v[132:135], v[228:231], v[60:63], v[132:135]
    v_add_f32 v114, v114, v117
    v_add_f32 v113, v113, v116
    v_mfma_f32_16x16x32_bf16 v[128:131], v[224:227], v[168:171], v[128:131]
    s_waitcnt lgkmcnt(5)
    v_cmp_ne_u32 vcc, s54, v18
    v_mfma_f32_16x16x32_bf16 v[132:135], v[224:227], v[172:175], v[132:135]
    v_add_f32 v115, v115, v118
    v_add_f32_dpp v114, v112, v114 row_ror:8 row_mask:0xf bank_mask:0x3
    v_mfma_f32_16x16x32_bf16 v[128:131], v[220:223], v[64:67], v[128:131]
    s_cbranch_vccnz L_gate_slow2
L_gate_ok2:
    v_add_f32_dpp v115, v113, v115 row_ror:8 row_mask:0xf bank_mask:0x3
    v_mfma_f32_16x16x32_bf16 v[132:135], v[220:223], v[68:71], v[132:135]
    ds_read_b64 v[136:137], v23 offset:768
    v_add_f32_dpp v112, v119, v114 row_ror:8 row_mask:0xf bank_mask:0xc
    v_mfma_f32_16x16x32_bf16 v[128:131], v[216:219], v[72:75], v[128:131]
    ds_read_b64 v[138:139], v23 offset:776
    v_mfma_f32_16x16x32_bf16 v[132:135], v[216:219], v[84:87], v[132:135]
    ds_read_b64 v[140:141], v23 offset:1984
    v_mfma_f32_16x16x32_bf16 v[128:131], v[212:215], v[88:91], v[128:131]
    ds_read_b64 v[142:143], v23 offset:1992
    v_mfma_f32_16x16x32_bf16 v[132:135], v[212:215], v[96:99], v[132:135]
    ds_write_b32 v21, v115 offset:46144
    v_mfma_f32_16x16x32_bf16 v[128:131], v[208:211], v[120:123], v[128:131]
    ds_read_b64 v[144:145], v23 offset:832
    v_mov_b32_dpp v113, v115 quad_perm:[0,1,2,3] row_mask:0xf bank_mask:0xc
    v_mfma_f32_16x16x32_bf16 v[132:135], v[208:211], v[124:127], v[132:135]
    ds_read_b64 v[146:147], v23 offset:840
    v_mov_b32_dpp v114, v119 quad_perm:[0,1,2,3] row_mask:0xf bank_mask:0xc
    v_mfma_f32_16x16x32_bf16 v[128:131], v[204:207], v[40:43], v[128:131]
    ds_write_b32 v21, v112 offset:42880
    v_mfma_f32_16x16x32_bf16 v[132:135], v[204:207], v[44:47], v[132:135]
    ds_write_b32 v21, v113 offset:43968
    v_mfma_f32_16x16x32_bf16 v[128:131], v[200:203], v[176:179], v[128:131]
    ds_write_b32 v21, v114 offset:45056
    v_mfma_f32_16x16x32_bf16 v[132:135], v[200:203], v[180:183], v[132:135]
    ds_write_b8 v26, v29 offset:40
    v_mfma_f32_16x16x32_bf16 v[128:131], v[196:199], v[184:187], v[128:131]
    ds_read_b64 v[148:149], v23 offset:2048
    v_add_f32 v54, v54, v57
    v_mfma_f32_16x16x32_bf16 v[132:135], v[196:199], v[188:191], v[132:135]
    ds_read_b64 v[150:151], v23 offset:2056
    s_waitcnt lgkmcnt(8)
    v_mfma_f32_16x16x32_bf16 v[128:131], v[192:195], v[136:139], v[128:131]
    ds_read_b64 v[152:153], v23 offset:896
    v_add_f32 v53, v53, v56
    v_mfma_f32_16x16x32_bf16 v[132:135], v[192:195], v[140:143], v[132:135]
    ds_read_b64 v[154:155], v23 offset:904
    v_add_f32 v55, v55, v58
    v_mfma_f32_16x16x32_bf16 v[156:159], v[244:247], v[0:3], 0
    ds_read_b64 v[160:161], v23 offset:2112
    v_add_f32_dpp v54, v52, v54 row_ror:8 row_mask:0xf bank_mask:0x3
    v_mfma_f32_16x16x32_bf16 v[164:167], v[244:247], v[4:7], 0
    ds_read_b64 v[162:163], v23 offset:2120
    v_add_f32_dpp v55, v53, v55 row_ror:8 row_mask:0xf bank_mask:0x3
    v_mfma_f32_16x16x32_bf16 v[156:159], v[240:243], v[8:11], v[156:159]
    v_add_f32_dpp v52, v59, v54 row_ror:8 row_mask:0xf bank_mask:0xc
    v_mfma_f32_16x16x32_bf16 v[164:167], v[240:243], v[12:15], v[164:167]
    ds_write_b32 v21, v55 offset:50432
    v_mfma_f32_16x16x32_bf16 v[156:159], v[236:239], v[32:35], v[156:159]
    v_mov_b32_dpp v53, v55 quad_perm:[0,1,2,3] row_mask:0xf bank_mask:0xc
    v_mov_b32_dpp v54, v59 quad_perm:[0,1,2,3] row_mask:0xf bank_mask:0xc
    v_mfma_f32_16x16x32_bf16 v[164:167], v[236:239], v[36:39], v[164:167]
    ds_write_b32 v21, v52 offset:47168
    v_mfma_f32_16x16x32_bf16 v[156:159], v[232:235], v[48:51], v[156:159]
    ds_write_b32 v21, v53 offset:48256
    v_mfma_f32_16x16x32_bf16 v[164:167], v[232:235], v[60:63], v[164:167]
    ds_write_b32 v21, v54 offset:49344
    v_mfma_f32_16x16x32_bf16 v[156:159], v[228:231], v[168:171], v[156:159]
    ds_write_b8 v26, v29 offset:44
    v_mfma_f32_16x16x32_bf16 v[164:167], v[228:231], v[172:175], v[164:167]
    v_add_u32 v21, 51456, v21
    v_add_f32 v130, v130, v133
    v_mfma_f32_16x16x32_bf16 v[156:159], v[224:227], v[64:67], v[156:159]
    v_add_f32 v129, v129, v132
    v_add_f32 v131, v131, v134
    v_mfma_f32_16x16x32_bf16 v[164:167], v[224:227], v[68:71], v[164:167]
    v_add_f32_dpp v130, v128, v130 row_ror:8 row_mask:0xf bank_mask:0x3
    v_add_f32_dpp v131, v129, v131 row_ror:8 row_mask:0xf bank_mask:0x3
    v_mfma_f32_16x16x32_bf16 v[156:159], v[220:223], v[72:75], v[156:159]
    v_add_f32_dpp v128, v135, v130 row_ror:8 row_mask:0xf bank_mask:0xc
    v_mfma_f32_16x16x32_bf16 v[164:167], v[220:223], v[84:87], v[164:167]
    ds_write_b32 v21, v131 offset:3264
    v_mfma_f32_16x16x32_bf16 v[156:159], v[216:219], v[88:91], v[156:159]
    v_mov_b32_dpp v129, v131 quad_perm:[0,1,2,3] row_mask:0xf bank_mask:0xc
    v_mov_b32_dpp v130, v135 quad_perm:[0,1,2,3] row_mask:0xf bank_mask:0xc
    v_mfma_f32_16x16x32_bf16 v[164:167], v[216:219], v[96:99], v[164:167]
    ds_write_b32 v21, v128 offset:0
    v_mfma_f32_16x16x32_bf16 v[156:159], v[212:215], v[120:123], v[156:159]
    ds_write_b32 v21, v129 offset:1088
    v_mfma_f32_16x16x32_bf16 v[164:167], v[212:215], v[124:127], v[164:167]
    ds_write_b32 v21, v130 offset:2176
    v_mfma_f32_16x16x32_bf16 v[156:159], v[208:211], v[40:43], v[156:159]
    ds_write_b8 v26, v29 offset:48
    v_mfma_f32_16x16x32_bf16 v[164:167], v[208:211], v[44:47], v[164:167]
    v_mfma_f32_16x16x32_bf16 v[156:159], v[204:207], v[176:179], v[156:159]
    v_mfma_f32_16x16x32_bf16 v[164:167], v[204:207], v[180:183], v[164:167]
    v_mfma_f32_16x16x32_bf16 v[156:159], v[200:203], v[184:187], v[156:159]
    v_mfma_f32_16x16x32_bf16 v[164:167], v[200:203], v[188:191], v[164:167]
    v_mfma_f32_16x16x32_bf16 v[156:159], v[196:199], v[136:139], v[156:159]
    v_mfma_f32_16x16x32_bf16 v[164:167], v[196:199], v[140:143], v[164:167]
    s_waitcnt lgkmcnt(1)
    v_mfma_f32_16x16x32_bf16 v[156:159], v[192:195], v[144:147], v[156:159]
    v_mfma_f32_16x16x32_bf16 v[164:167], v[192:195], v[148:151], v[164:167]
    s_nop 2
    v_mfma_f32_16x16x32_bf16 v[76:79], v[248:251], v[0:3], 0
    s_nop 2
    v_mfma_f32_16x16x32_bf16 v[80:83], v[248:251], v[4:7], 0
    ds_read_b64 v[92:93], v23 offset:960
    v_add_f32 v158, v158, v165
    v_mfma_f32_16x16x32_bf16 v[76:79], v[244:247], v[8:11], v[76:79]
    ds_read_b64 v[94:95], v23 offset:968
    v_add_f32 v157, v157, v164
    v_mfma_f32_16x16x32_bf16 v[80:83], v[244:247], v[12:15], v[80:83]
    ds_read_b64 v[100:101], v23 offset:2176
    v_add_f32 v159, v159, v166
    v_mfma_f32_16x16x32_bf16 v[76:79], v[240:243], v[32:35], v[76:79]
    ds_read_b64 v[102:103], v23 offset:2184
    v_add_f32_dpp v158, v156, v158 row_ror:8 row_mask:0xf bank_mask:0x3
    v_mfma_f32_16x16x32_bf16 v[80:83], v[240:243], v[36:39], v[80:83]
    v_add_f32_dpp v159, v157, v159 row_ror:8 row_mask:0xf bank_mask:0x3
    v_add_f32_dpp v156, v167, v158 row_ror:8 row_mask:0xf bank_mask:0xc
    v_mfma_f32_16x16x32_bf16 v[76:79], v[236:239], v[48:51], v[76:79]
    ds_write_b32 v21, v159 offset:7552
    v_mfma_f32_16x16x32_bf16 v[80:83], v[236:239], v[60:63], v[80:83]
    v_mov_b32_dpp v157, v159 quad_perm:[0,1,2,3] row_mask:0xf bank_mask:0xc
    v_mov_b32_dpp v158, v167 quad_perm:[0,1,2,3] row_mask:0xf bank_mask:0xc
    v_mfma_f32_16x16x32_bf16 v[76:79], v[232:235], v[168:171], v[76:79]
    ds_write_b32 v21, v156 offset:4288
    v_mfma_f32_16x16x32_bf16 v[80:83], v[232:235], v[172:175], v[80:83]
    ds_write_b32 v21, v157 offset:5376
    v_mfma_f32_16x16x32_bf16 v[76:79], v[228:231], v[64:67], v[76:79]
    ds_write_b32 v21, v158 offset:6464
    v_mfma_f32_16x16x32_bf16 v[80:83], v[228:231], v[68:71], v[80:83]
    ds_write_b8 v26, v29 offset:52
    v_mfma_f32_16x16x32_bf16 v[76:79], v[224:227], v[72:75], v[76:79]
    v_mfma_f32_16x16x32_bf16 v[80:83], v[224:227], v[84:87], v[80:83]
    v_mfma_f32_16x16x32_bf16 v[76:79], v[220:223], v[88:91], v[76:79]
    v_mfma_f32_16x16x32_bf16 v[80:83], v[220:223], v[96:99], v[80:83]
    v_mfma_f32_16x16x32_bf16 v[76:79], v[216:219], v[120:123], v[76:79]
    v_mfma_f32_16x16x32_bf16 v[80:83], v[216:219], v[124:127], v[80:83]
    v_mfma_f32_16x16x32_bf16 v[76:79], v[212:215], v[40:43], v[76:79]
    v_mfma_f32_16x16x32_bf16 v[80:83], v[212:215], v[44:47], v[80:83]
    v_mfma_f32_16x16x32_bf16 v[76:79], v[208:211], v[176:179], v[76:79]
    v_mfma_f32_16x16x32_bf16 v[80:83], v[208:211], v[180:183], v[80:83]
    v_mfma_f32_16x16x32_bf16 v[76:79], v[204:207], v[184:187], v[76:79]
    v_mfma_f32_16x16x32_bf16 v[80:83], v[204:207], v[188:191], v[80:83]
    v_mfma_f32_16x16x32_bf16 v[76:79], v[200:203], v[136:139], v[76:79]
    v_mfma_f32_16x16x32_bf16 v[80:83], v[200:203], v[140:143], v[80:83]
    v_mfma_f32_16x16x32_bf16 v[76:79], v[196:199], v[144:147], v[76:79]
    v_mfma_f32_16x16x32_bf16 v[80:83], v[196:199], v[148:151], v[80:83]
    v_mfma_f32_16x16x32_bf16 v[76:79], v[192:195], v[152:155], v[76:79]
    v_mfma_f32_16x16x32_bf16 v[80:83], v[192:195], v[160:163], v[80:83]
    s_nop 2
    v_mfma_f32_16x16x32_bf16 v[104:107], v[252:255], v[0:3], 0
    s_nop 2
    v_mfma_f32_16x16x32_bf16 v[108:111], v[252:255], v[4:7], 0
    v_add_f32 v78, v78, v81
    v_add_f32 v77, v77, v80
    v_mfma_f32_16x16x32_bf16 v[104:107], v[248:251], v[8:11], v[104:107]
    v_add_f32 v79, v79, v82
    v_add_f32_dpp v78, v76, v78 row_ror:8 row_mask:0xf bank_mask:0x3
    v_mfma_f32_16x16x32_bf16 v[108:111], v[248:251], v[12:15], v[108:111]
    v_add_f32_dpp v79, v77, v79 row_ror:8 row_mask:0xf bank_mask:0x3
    v_add_f32_dpp v76, v83, v78 row_ror:8 row_mask:0xf bank_mask:0xc
    v_mfma_f32_16x16x32_bf16 v[104:107], v[244:247], v[32:35], v[104:107]
    ds_write_b32 v21, v79 offset:11840
    v_mfma_f32_16x16x32_bf16 v[108:111], v[244:247], v[36:39], v[108:111]
    v_mov_b32_dpp v77, v79 quad_perm:[0,1,2,3] row_mask:0xf bank_mask:0xc
    v_mov_b32_dpp v78, v83 quad_perm:[0,1,2,3] row_mask:0xf bank_mask:0xc
    v_mfma_f32_16x16x32_bf16 v[104:107], v[240:243], v[48:51], v[104:107]
    ds_write_b32 v21, v76 offset:8576
    v_mfma_f32_16x16x32_bf16 v[108:111], v[240:243], v[60:63], v[108:111]
    ds_write_b32 v21, v77 offset:9664
    v_mfma_f32_16x16x32_bf16 v[104:107], v[236:239], v[168:171], v[104:107]
    ds_write_b32 v21, v78 offset:10752
    v_mfma_f32_16x16x32_bf16 v[108:111], v[236:239], v[172:175], v[108:111]
    ds_write_b8 v26, v29 offset:56
    v_mfma_f32_16x16x32_bf16 v[104:107], v[232:235], v[64:67], v[104:107]
    v_mfma_f32_16x16x32_bf16 v[108:111], v[232:235], v[68:71], v[108:111]
    v_mfma_f32_16x16x32_bf16 v[104:107], v[228:231], v[72:75], v[104:107]
    v_mfma_f32_16x16x32_bf16 v[108:111], v[228:231], v[84:87], v[108:111]
    v_mfma_f32_16x16x32_bf16 v[104:107], v[224:227], v[88:91], v[104:107]
    v_mfma_f32_16x16x32_bf16 v[108:111], v[224:227], v[96:99], v[108:111]
    v_mfma_f32_16x16x32_bf16 v[104:107], v[220:223], v[120:123], v[104:107]
    v_mfma_f32_16x16x32_bf16 v[108:111], v[220:223], v[124:127], v[108:111]
    v_mfma_f32_16x16x32_bf16 v[104:107], v[216:219], v[40:43], v[104:107]
    v_mfma_f32_16x16x32_bf16 v[108:111], v[216:219], v[44:47], v[108:111]
    v_mfma_f32_16x16x32_bf16 v[104:107], v[212:215], v[176:179], v[104:107]
    v_mfma_f32_16x16x32_bf16 v[108:111], v[212:215], v[180:183], v[108:111]
    v_mfma_f32_16x16x32_bf16 v[104:107], v[208:211], v[184:187], v[104:107]
    v_mfma_f32_16x16x32_bf16 v[108:111], v[208:211], v[188:191], v[108:111]
    v_mfma_f32_16x16x32_bf16 v[104:107], v[204:207], v[136:139], v[104:107]
    v_mfma_f32_16x16x32_bf16 v[108:111], v[204:207], v[140:143], v[108:111]
    v_mfma_f32_16x16x32_bf16 v[104:107], v[200:203], v[144:147], v[104:107]
    v_mfma_f32_16x16x32_bf16 v[108:111], v[200:203], v[148:151], v[108:111]
    v_mfma_f32_16x16x32_bf16 v[104:107], v[196:199], v[152:155], v[104:107]
    v_mfma_f32_16x16x32_bf16 v[108:111], v[196:199], v[160:163], v[108:111]
    s_waitcnt lgkmcnt(0)
    v_mfma_f32_16x16x32_bf16 v[104:107], v[192:195], v[92:95], v[104:107]
    v_mfma_f32_16x16x32_bf16 v[108:111], v[192:195], v[100:103], v[108:111]
    s_nop 7
    v_add_f32 v106, v106, v109
    v_add_f32 v105, v105, v108
    v_add_f32 v107, v107, v110
    v_add_f32_dpp v106, v104, v106 row_ror:8 row_mask:0xf bank_mask:0x3
    s_nop 0
    v_add_f32_dpp v107, v105, v107 row_ror:8 row_mask:0xf bank_mask:0x3
    v_add_f32_dpp v104, v111, v106 row_ror:8 row_mask:0xf bank_mask:0xc
    ds_write_b32 v21, v107 offset:16128
    v_mov_b32_dpp v105, v107 quad_perm:[0,1,2,3] row_mask:0xf bank_mask:0xc
    v_mov_b32_dpp v106, v111 quad_perm:[0,1,2,3] row_mask:0xf bank_mask:0xc
    ds_write_b32 v21, v104 offset:12864
    ds_write_b32 v21, v105 offset:13952
    ds_write_b32 v21, v106 offset:15040
    ds_write_b8 v26, v29 offset:60
    s_branch L_done
L_gate_slow0:
    s_mov_b32 s58, 0
L_gate_spin0:
    ds_read_b64 v[18:19], v30
    s_add_u32 s58, s58, 1
    s_waitcnt lgkmcnt(0)
    v_cmp_ne_u64 vcc, s[54:55], v[18:19]
    s_cmp_gt_u32 s58, 4194304
    s_cbranch_scc1 L_gate_out0
    s_cbranch_vccnz L_gate_spin0
L_gate_out0:
    s_cmp_eq_u32 0, 1
    s_branch L_gate_ok0
L_gate_slow1:
    s_mov_b32 s58, 0
L_gate_spin1:
    ds_read_b32 v18, v30 offset:8
    s_add_u32 s58, s58, 1
    s_waitcnt lgkmcnt(0)
    v_cmp_ne_u32 vcc, s54, v18
    s_cmp_gt_u32 s58, 4194304
    s_cbranch_scc1 L_gate_out1
    s_cbranch_vccnz L_gate_spin1
L_gate_out1:
    s_cmp_eq_u32 0, 1
    s_branch L_gate_ok1
L_gate_slow2:
    s_mov_b32 s58, 0
L_gate_spin2:
    ds_read_b32 v18, v30 offset:12
    s_add_u32 s58, s58, 1
    s_waitcnt lgkmcnt(0)
    v_cmp_ne_u32 vcc, s54, v18
    s_cmp_gt_u32 s58, 4194304
    s_cbranch_scc1 L_gate_out2
    s_cbranch_vccnz L_gate_spin2
L_gate_out2:
    s_cmp_eq_u32 0, 1
    s_branch L_gate_ok2
.p2align 12
L_conv1:
    s_load_dword s80, s[38:39], 28672
    v_mov_b32 v209, v5
    v_add_u32 v221, 0x100000, v5
    v_add_u32 v222, 0x180000, v5
    s_mul_i32 s48, s40, 9216
    s_mul_i32 s49, s40, 6912
    s_mov_b32 m0, s48
    s_add_u32 s50, s49, 73728
    v_mov_b32 v72, 0x3c00
    ds_write_addtid_b32 v72
    s_add_u32 s49, s49, 14848
    s_mov_b32 s52, 0x7fff7fff
    s_lshl_b32 s85, s40, 4
    s_sub_u32 s44, s40, 4
    v_and_b32 v3, 3, v9
    v_lshrrev_b32 v4, 2, v9
    v_lshrrev_b32 v8, 10, v5
    v_lshrrev_b32 v8, 3, v8
    v_lshl_add_u32 v208, v8, 2, v3
    v_lshlrev_b32 v208, 3, v208
    v_add_u32 v208, 0x1000, v208
    s_movk_i32 s46, 1216
    v_mul_u32_u24 v220, s46, v3
    v_lshl_add_u32 v220, v8, 2, v220
    v_add_u32 v220, 129160, v220
    v_lshrrev_b32 v8, 3, v9
    v_and_b32 v6, 1, v4
    v_lshl_add_u32 v7, v6, 5, v8
    v_subrev_u32 v34, 16, v7
    v_add_u32 v35, 47, v8
    v_cmp_eq_u32 s[54:55], 0, v6
    v_cmp_eq_u32 s[60:61], 0, v7
    v_mov_b32 v36, -213
    v_cndmask_b32 v34, v34, v35, s[54:55]
    v_cndmask_b32 v34, v34, v36, s[60:61]
    s_mul_i32 s46, s44, 4288
    v_lshl_add_u32 v7, v7, 4, s46
    v_lshl_add_u32 v34, v34, 4, s46
    s_movk_i32 s47, 1088
    v_mad_u32_u24 v210, v3, s47, v7
    v_mad_u32_u24 v213, v3, s47, v34
    v_add_u32 v213, 128, v213
    v_add_u32 v214, 128, v210
    v_cmp_eq_u32 s[62:63], 3, v3
    s_add_u32 s46, s46, 1024
    v_mov_b32 v36, s46
    s_cmp_eq_u32 s44, 0
    s_cselect_b64 s[60:61], s[60:61], 0
    v_cndmask_b32 v213, v213, v36, s[62:63]
    v_cndmask_b32 v214, v214, v36, s[62:63]
    v_cndmask_b32 v216, v213, v36, s[60:61]
    v_add_u32 v213, 17152, v213
    s_lshl2_add_u32 s46, s44, 148496
    v_mov_b32 v217, s46
    s_add_u32 s46, s44, 148564
    v_mov_b32 v218, s46
    s_lshr_b32 s46, s43, 5
    s_and_b32 s47, s43, 1
    s_lshl1_add_u32 s46, s46, s47
    s_bfe_u32 s47, s43, 0x40001
    s_lshl4_add_u32 s46, s46, s47
    s_lshl_b32 s46, s46, 4
    s_add_u32 s46, s46, 36864
    v_lshl_add_u32 v219, v3, 2, s46
    v_lshl_add_u32 v219, v4, 13, v219
    v_mov_b32 v224, 0
    v_mov_b32 v225, 0
    v_mov_b32 v226, 0
    v_mov_b32 v227, 0
    v_mov_b32 v228, 1
    s_mov_b64 s[56:57], s[34:35]
    v_mov_b32 v229, 148592
    v_lshl_add_u32 v230, v3, 2, v229
    s_mov_b32 s82, 0x05040100
    s_mov_b32 s84, 16843009
    s_mov_b32 s83, 0x07060302
    s_waitcnt vmcnt(7)
    s_setprio 3
    v_and_b32 v10, 0xffff0000, v10
    s_waitcnt lgkmcnt(0)
    s_lshr_b64 s[86:87], s[86:87], s85
    s_lshl_b32 s86, s86, 16
    v_mov_b32 v14, 1069066811
    v_mul_f32 v10, v14, v10
    v_mul_f32 v14, s86, v14
    v_exp_f32 v14, v14
    v_exp_f32 v10, v10
    v_and_b32 v11, 0xffff0000, v11
    v_mul_f32 v11, 1042479491, v11
    v_cvt_pk_bf16_f32 v10, v10, v14
    v_and_b32 v14, 0xffff0000, v10
    v_lshlrev_b32 v10, 16, v10
    v_mul_f32 v11, v11, v14
    v_mul_f32 v10, v10, v14
    v_mul_f32 v55, 0x41000000, v11
    v_mul_f32 v54, 0xc138aa3b, v10
    v_fract_f32 v55, v55
    v_exp_f32 v54, v54
    v_cos_f32 v52, v55
    v_sin_f32 v53, v55
    s_nop 0
    v_pk_mul_f32 v[52:53], v[52:53], v[54:55] op_sel_hi:[1,0]
    v_cvt_pk_f16_f32 v63, v52, v53
    v_pk_mul_f32 v[58:59], v[52:53], v[52:53] op_sel:[0,0] op_sel_hi:[0,1]
    v_pk_fma_f32 v[52:53], v[52:53], v[52:53], v[58:59] op_sel:[1,1,0] op_sel_hi:[1,0,1] neg_lo:[1,0,0]
    ds_write_addtid_b32 v63 offset:288
    v_cvt_pk_f16_f32 v64, v52, v53
    v_pk_mul_f32 v[58:59], v[52:53], v[52:53] op_sel:[0,0] op_sel_hi:[0,1]
    v_pk_fma_f32 v[52:53], v[52:53], v[52:53], v[58:59] op_sel:[1,1,0] op_sel_hi:[1,0,1] neg_lo:[1,0,0]
    ds_write_addtid_b32 v64 offset:576
    v_pk_mul_f16 v75, v63, v64 op_sel:[0,0] op_sel_hi:[1,0]
    v_pk_fma_f16 v75, v63, v64, v75 op_sel:[1,1,0] op_sel_hi:[0,1,1] neg_lo:[1,0,0]
    ds_write_addtid_b32 v75 offset:864
    v_mul_f32 v10, 3216550459, v10
    v_fract_f32 v11, v11
    v_exp_f32 v10, v10
    v_cvt_pk_f16_f32 v65, v52, v53
    v_pk_mul_f32 v[58:59], v[52:53], v[52:53] op_sel:[0,0] op_sel_hi:[0,1]
    v_pk_fma_f32 v[52:53], v[52:53], v[52:53], v[58:59] op_sel:[1,1,0] op_sel_hi:[1,0,1] neg_lo:[1,0,0]
    ds_write_addtid_b32 v65 offset:1152
    v_pk_mul_f16 v77, v63, v65 op_sel:[0,0] op_sel_hi:[1,0]
    v_pk_mul_f16 v78, v64, v65 op_sel:[0,0] op_sel_hi:[1,0]
    v_pk_fma_f16 v77, v63, v65, v77 op_sel:[1,1,0] op_sel_hi:[0,1,1] neg_lo:[1,0,0]
    v_pk_fma_f16 v78, v64, v65, v78 op_sel:[1,1,0] op_sel_hi:[0,1,1] neg_lo:[1,0,0]
    ds_write_addtid_b32 v77 offset:1440
    ds_write_addtid_b32 v78 offset:1728
    v_cos_f32 v50, v11
    v_sin_f32 v51, v11
    v_mul_f32 v50, v50, v10
    v_pk_mul_f16 v79, v75, v65 op_sel:[0,0] op_sel_hi:[1,0]
    v_pk_fma_f16 v79, v75, v65, v79 op_sel:[1,1,0] op_sel_hi:[0,1,1] neg_lo:[1,0,0]
    ds_write_addtid_b32 v79 offset:2016
    v_mul_f32 v51, v51, v10
    v_cvt_pk_f16_f32 v60, v50, v51
    s_waitcnt vmcnt(5)
    v_and_b32 v46, s52, v12
    v_cvt_pk_f16_f32 v66, v52, v53
    v_pk_mul_f32 v[58:59], v[52:53], v[52:53] op_sel:[0,0] op_sel_hi:[0,1]
    v_pk_fma_f32 v[52:53], v[52:53], v[52:53], v[58:59] op_sel:[1,1,0] op_sel_hi:[1,0,1] neg_lo:[1,0,0]
    ds_write_addtid_b32 v66 offset:2304
    v_pk_mul_f16 v81, v63, v66 op_sel:[0,0] op_sel_hi:[1,0]
    v_pk_mul_f16 v82, v64, v66 op_sel:[0,0] op_sel_hi:[1,0]
    v_pk_fma_f16 v81, v63, v66, v81 op_sel:[1,1,0] op_sel_hi:[0,1,1] neg_lo:[1,0,0]
    v_pk_fma_f16 v82, v64, v66, v82 op_sel:[1,1,0] op_sel_hi:[0,1,1] neg_lo:[1,0,0]
    ds_write_addtid_b32 v81 offset:2592
    ds_write_addtid_b32 v82 offset:2880
    v_and_b32 v47, s52, v13
    v_pk_max_u16 v46, v46, v47
    v_pk_max_u16 v46, v46, v46 op_sel:[0,1] op_sel_hi:[1,0]
    v_pk_mul_f16 v83, v75, v66 op_sel:[0,0] op_sel_hi:[1,0]
    v_pk_mul_f16 v84, v65, v66 op_sel:[0,0] op_sel_hi:[1,0]
    v_pk_fma_f16 v83, v75, v66, v83 op_sel:[1,1,0] op_sel_hi:[0,1,1] neg_lo:[1,0,0]
    v_pk_fma_f16 v84, v65, v66, v84 op_sel:[1,1,0] op_sel_hi:[0,1,1] neg_lo:[1,0,0]
    ds_write_addtid_b32 v83 offset:3168
    ds_write_addtid_b32 v84 offset:3456
    v_and_b32 v12, 0xffff0000, v12
    v_and_b32 v13, 0xffff0000, v13
    v_max_u32_dpp v46, v46, v46 row_shr:1 row_mask:0xf bank_mask:0xf
    v_pk_mul_f16 v85, v77, v66 op_sel:[0,0] op_sel_hi:[1,0]
    v_pk_mul_f16 v86, v78, v66 op_sel:[0,0] op_sel_hi:[1,0]
    v_pk_fma_f16 v85, v77, v66, v85 op_sel:[1,1,0] op_sel_hi:[0,1,1] neg_lo:[1,0,0]
    v_pk_fma_f16 v86, v78, v66, v86 op_sel:[1,1,0] op_sel_hi:[0,1,1] neg_lo:[1,0,0]
    ds_write_addtid_b32 v85 offset:3744
    ds_write_addtid_b32 v86 offset:4032
    v_pk_mul_f32 v[56:57], v[50:51], v[50:51] op_sel:[0,0] op_sel_hi:[0,1]
    s_nop 0
    v_max_u32_dpp v46, v46, v46 row_shr:2 row_mask:0xf bank_mask:0xf
    v_pk_fma_f32 v[50:51], v[50:51], v[50:51], v[56:57] op_sel:[1,1,0] op_sel_hi:[1,0,1] neg_lo:[1,0,0]
    v_pk_mul_f16 v87, v79, v66 op_sel:[0,0] op_sel_hi:[1,0]
    v_pk_fma_f16 v87, v79, v66, v87 op_sel:[1,1,0] op_sel_hi:[0,1,1] neg_lo:[1,0,0]
    ds_write_addtid_b32 v87 offset:4320
    s_nop 0
    v_max_u32_dpp v46, v46, v46 row_shr:4 row_mask:0xf bank_mask:0xf
    v_cvt_pk_f16_f32 v61, v50, v51
    s_nop 0
    v_max_u32_dpp v46, v46, v46 row_shr:8 row_mask:0xf bank_mask:0xf
    v_cvt_pk_f16_f32 v67, v52, v53
    ds_write_addtid_b32 v67 offset:4608
    s_setprio 2
    v_pk_mul_f16 v89, v63, v67 op_sel:[0,0] op_sel_hi:[1,0]
    v_pk_mul_f16 v90, v64, v67 op_sel:[0,0] op_sel_hi:[1,0]
    v_pk_fma_f16 v89, v63, v67, v89 op_sel:[1,1,0] op_sel_hi:[0,1,1] neg_lo:[1,0,0]
    v_pk_fma_f16 v90, v64, v67, v90 op_sel:[1,1,0] op_sel_hi:[0,1,1] neg_lo:[1,0,0]
    ds_write_addtid_b32 v89 offset:4896
    ds_write_addtid_b32 v90 offset:5184
    v_pk_mul_f32 v[58:59], v[52:53], v[52:53] op_sel:[0,0] op_sel_hi:[0,1]
    v_pk_fma_f32 v[52:53], v[52:53], v[52:53], v[58:59] op_sel:[1,1,0] op_sel_hi:[1,0,1] neg_lo:[1,0,0]
    v_pk_mul_f32 v[56:57], v[50:51], v[50:51] op_sel:[0,0] op_sel_hi:[0,1]
    s_nop 0
    v_max_u32_dpp v46, v46, v46 row_bcast:15 row_mask:0xa bank_mask:0xf
    v_pk_mul_f16 v91, v75, v67 op_sel:[0,0] op_sel_hi:[1,0]
    v_pk_mul_f16 v92, v65, v67 op_sel:[0,0] op_sel_hi:[1,0]
    v_pk_fma_f16 v91, v75, v67, v91 op_sel:[1,1,0] op_sel_hi:[0,1,1] neg_lo:[1,0,0]
    v_pk_fma_f16 v92, v65, v67, v92 op_sel:[1,1,0] op_sel_hi:[0,1,1] neg_lo:[1,0,0]
    ds_write_addtid_b32 v91 offset:5472
    ds_write_addtid_b32 v92 offset:5760
    v_cvt_pk_f16_f32 v68, v52, v53
    v_pk_mul_f32 v[58:59], v[52:53], v[52:53] op_sel:[0,0] op_sel_hi:[0,1]
    v_pk_fma_f32 v[50:51], v[50:51], v[50:51], v[56:57] op_sel:[1,1,0] op_sel_hi:[1,0,1] neg_lo:[1,0,0]
    s_nop 0
    v_max_u32_dpp v46, v46, v46 row_bcast:31 row_mask:0xc bank_mask:0xf
    v_pk_mul_f16 v93, v77, v67 op_sel:[0,0] op_sel_hi:[1,0]
    v_pk_mul_f16 v94, v78, v67 op_sel:[0,0] op_sel_hi:[1,0]
    v_pk_fma_f16 v93, v77, v67, v93 op_sel:[1,1,0] op_sel_hi:[0,1,1] neg_lo:[1,0,0]
    v_pk_fma_f16 v94, v78, v67, v94 op_sel:[1,1,0] op_sel_hi:[0,1,1] neg_lo:[1,0,0]
    ds_write_addtid_b32 v93 offset:6048
    ds_write_addtid_b32 v94 offset:6336
    v_pk_fma_f32 v[52:53], v[52:53], v[52:53], v[58:59] op_sel:[1,1,0] op_sel_hi:[1,0,1] neg_lo:[1,0,0]
    v_cvt_pk_f16_f32 v69, v52, v53
    v_cvt_pk_f16_f32 v62, v50, v51
    s_nop 0
    v_readlane_b32 s50, v46, 63
    v_pk_mul_f16 v95, v79, v67 op_sel:[0,0] op_sel_hi:[1,0]
    v_pk_mul_f16 v96, v66, v67 op_sel:[0,0] op_sel_hi:[1,0]
    v_pk_fma_f16 v95, v79, v67, v95 op_sel:[1,1,0] op_sel_hi:[0,1,1] neg_lo:[1,0,0]
    v_pk_fma_f16 v96, v66, v67, v96 op_sel:[1,1,0] op_sel_hi:[0,1,1] neg_lo:[1,0,0]
    ds_write_addtid_b32 v95 offset:6624
    ds_write_addtid_b32 v96 offset:6912
    v_pk_mul_f32 v[58:59], v[52:53], v[52:53] op_sel:[0,0] op_sel_hi:[0,1]
    v_pk_fma_f32 v[52:53], v[52:53], v[52:53], v[58:59] op_sel:[1,1,0] op_sel_hi:[1,0,1] neg_lo:[1,0,0]
    s_and_b32 s50, s50, 0x7f800000
    s_max_u32 s50, s50, 0x07000000
    s_sub_u32 s51, 2239758336, s50
    s_sub_u32 s50, s50, 100663296
    v_mul_f32 v12, s51, v12
    v_mul_f32 v13, s51, v13
    v_pk_mul_f16 v97, v81, v67 op_sel:[0,0] op_sel_hi:[1,0]
    v_pk_mul_f16 v98, v82, v67 op_sel:[0,0] op_sel_hi:[1,0]
    v_pk_fma_f16 v97, v81, v67, v97 op_sel:[1,1,0] op_sel_hi:[0,1,1] neg_lo:[1,0,0]
    v_pk_fma_f16 v98, v82, v67, v98 op_sel:[1,1,0] op_sel_hi:[0,1,1] neg_lo:[1,0,0]
    ds_write_addtid_b32 v97 offset:7200
    ds_write_addtid_b32 v98 offset:7488
    v_cvt_pk_f16_f32 v70, v52, v53
    v_cvt_pk_f16_f32 v104, v12, -v13
    v_pk_mul_f16 v99, v83, v67 op_sel:[0,0] op_sel_hi:[1,0]
    v_pk_mul_f16 v100, v84, v67 op_sel:[0,0] op_sel_hi:[1,0]
    v_pk_fma_f16 v99, v83, v67, v99 op_sel:[1,1,0] op_sel_hi:[0,1,1] neg_lo:[1,0,0]
    v_pk_fma_f16 v100, v84, v67, v100 op_sel:[1,1,0] op_sel_hi:[0,1,1] neg_lo:[1,0,0]
    ds_write_addtid_b32 v99 offset:7776
    ds_write_addtid_b32 v100 offset:8064
    v_pk_mul_f16 v101, v85, v67 op_sel:[0,0] op_sel_hi:[1,0]
    v_pk_mul_f16 v102, v86, v67 op_sel:[0,0] op_sel_hi:[1,0]
    v_pk_fma_f16 v101, v85, v67, v101 op_sel:[1,1,0] op_sel_hi:[0,1,1] neg_lo:[1,0,0]
    v_pk_fma_f16 v102, v86, v67, v102 op_sel:[1,1,0] op_sel_hi:[0,1,1] neg_lo:[1,0,0]
    ds_write_addtid_b32 v101 offset:8352
    ds_write_addtid_b32 v102 offset:8640
    v_pk_mul_f16 v103, v87, v67 op_sel:[0,0] op_sel_hi:[1,0]
    v_pk_fma_f16 v103, v87, v67, v103 op_sel:[1,1,0] op_sel_hi:[0,1,1] neg_lo:[1,0,0]
    ds_write_addtid_b32 v103 offset:8928
    s_setprio 1
    s_mov_b32 m0, s49
    s_nop 0
    ds_write_addtid_b32 v104 offset:60608
    v_pk_mul_f16 v105, v104, v60 op_sel:[0,0] op_sel_hi:[1,0]
    v_pk_mul_f16 v106, v104, v61 op_sel:[0,0] op_sel_hi:[1,0]
    v_pk_fma_f16 v105, v104, v60, v105 op_sel:[1,1,0] op_sel_hi:[0,1,1] neg_hi:[1,0,0]
    v_pk_fma_f16 v106, v104, v61, v106 op_sel:[1,1,0] op_sel_hi:[0,1,1] neg_hi:[1,0,0]
    ds_write_addtid_b32 v105 offset:61472
    ds_write_addtid_b32 v106 offset:60032
    v_pk_mul_f16 v108, v104, v62 op_sel:[0,0] op_sel_hi:[1,0]
    v_pk_mul_f16 v112, v104, v68 op_sel:[0,0] op_sel_hi:[1,0]
    v_pk_fma_f16 v108, v104, v62, v108 op_sel:[1,1,0] op_sel_hi:[0,1,1] neg_hi:[1,0,0]
    v_pk_fma_f16 v112, v104, v68, v112 op_sel:[1,1,0] op_sel_hi:[0,1,1] neg_hi:[1,0,0]
    ds_write_addtid_b32 v108 offset:61760
    ds_write_addtid_b32 v112 offset:58880
    v_pk_mul_f16 v117, v104, v69 op_sel:[0,0] op_sel_hi:[1,0]
    v_pk_mul_f16 v123, v104, v70 op_sel:[0,0] op_sel_hi:[1,0]
    v_pk_fma_f16 v117, v104, v69, v117 op_sel:[1,1,0] op_sel_hi:[0,1,1] neg_hi:[1,0,0]
    v_pk_fma_f16 v123, v104, v70, v123 op_sel:[1,1,0] op_sel_hi:[0,1,1] neg_hi:[1,0,0]
    ds_write_addtid_b32 v117 offset:65504
    ds_write_addtid_b32 v123 offset:63488
    v_pk_mul_f16 v107, v106, v60 op_sel:[0,0] op_sel_hi:[1,0]
    v_pk_mul_f16 v109, v108, v60 op_sel:[0,0] op_sel_hi:[1,0]
    v_pk_fma_f16 v107, v106, v60, v107 op_sel:[1,1,0] op_sel_hi:[0,1,1] neg_hi:[1,0,0]
    v_pk_fma_f16 v109, v108, v60, v109 op_sel:[1,1,0] op_sel_hi:[0,1,1] neg_hi:[1,0,0]
    ds_write_addtid_b32 v107 offset:61184
    ds_write_addtid_b32 v109 offset:60320
    v_pk_mul_f16 v110, v108, v61 op_sel:[0,0] op_sel_hi:[1,0]
    v_pk_mul_f16 v113, v106, v68 op_sel:[0,0] op_sel_hi:[1,0]
    v_pk_fma_f16 v110, v108, v61, v110 op_sel:[1,1,0] op_sel_hi:[0,1,1] neg_hi:[1,0,0]
    v_pk_fma_f16 v113, v106, v68, v113 op_sel:[1,1,0] op_sel_hi:[0,1,1] neg_hi:[1,0,0]
    ds_write_addtid_b32 v110 offset:59168
    ds_write_addtid_b32 v113 offset:62336
    v_pk_mul_f16 v114, v108, v68 op_sel:[0,0] op_sel_hi:[1,0]
    v_pk_mul_f16 v118, v108, v69 op_sel:[0,0] op_sel_hi:[1,0]
    v_pk_fma_f16 v114, v108, v68, v114 op_sel:[1,1,0] op_sel_hi:[0,1,1] neg_hi:[1,0,0]
    v_pk_fma_f16 v118, v108, v69, v118 op_sel:[1,1,0] op_sel_hi:[0,1,1] neg_hi:[1,0,0]
    ds_write_addtid_b32 v114 offset:60896
    ds_write_addtid_b32 v118 offset:64640
    v_pk_mul_f16 v120, v112, v69 op_sel:[0,0] op_sel_hi:[1,0]
    v_pk_mul_f16 v124, v112, v70 op_sel:[0,0] op_sel_hi:[1,0]
    v_pk_fma_f16 v120, v112, v69, v120 op_sel:[1,1,0] op_sel_hi:[0,1,1] neg_hi:[1,0,0]
    v_pk_fma_f16 v124, v112, v70, v124 op_sel:[1,1,0] op_sel_hi:[0,1,1] neg_hi:[1,0,0]
    ds_write_addtid_b32 v120 offset:65216
    ds_write_addtid_b32 v124 offset:64064
    v_pk_mul_f16 v125, v117, v70 op_sel:[0,0] op_sel_hi:[1,0]
    v_pk_mul_f16 v127, v123, v70 op_sel:[0,0] op_sel_hi:[1,0]
    v_pk_fma_f16 v125, v117, v70, v125 op_sel:[1,1,0] op_sel_hi:[0,1,1] neg_hi:[1,0,0]
    v_pk_fma_f16 v127, v123, v70, v127 op_sel:[1,1,0] op_sel_hi:[0,1,1] neg_hi:[1,0,0]
    ds_write_addtid_b32 v125 offset:63200
    ds_write_addtid_b32 v127 offset:62912
    v_pk_mul_f16 v116, v112, v63 op_sel:[0,0] op_sel_hi:[1,0]
    v_pk_mul_f16 v119, v117, v63 op_sel:[0,0] op_sel_hi:[1,0]
    v_pk_fma_f16 v116, v112, v63, v116 op_sel:[1,1,0] op_sel_hi:[0,1,1] neg_hi:[1,0,0]
    v_pk_fma_f16 v119, v117, v63, v119 op_sel:[1,1,0] op_sel_hi:[0,1,1] neg_hi:[1,0,0]
    ds_write_addtid_b32 v116 offset:59456
    ds_write_addtid_b32 v119 offset:62624
    v_pk_mul_f16 v111, v110, v60 op_sel:[0,0] op_sel_hi:[1,0]
    v_pk_mul_f16 v115, v110, v68 op_sel:[0,0] op_sel_hi:[1,0]
    v_pk_fma_f16 v111, v110, v60, v111 op_sel:[1,1,0] op_sel_hi:[0,1,1] neg_hi:[1,0,0]
    v_pk_fma_f16 v115, v110, v68, v115 op_sel:[1,1,0] op_sel_hi:[0,1,1] neg_hi:[1,0,0]
    ds_write_addtid_b32 v111 offset:59744
    ds_write_addtid_b32 v115 offset:62048
    v_pk_mul_f16 v121, v114, v69 op_sel:[0,0] op_sel_hi:[1,0]
    v_pk_mul_f16 v126, v120, v70 op_sel:[0,0] op_sel_hi:[1,0]
    v_pk_fma_f16 v121, v114, v69, v121 op_sel:[1,1,0] op_sel_hi:[0,1,1] neg_hi:[1,0,0]
    v_pk_fma_f16 v126, v120, v70, v126 op_sel:[1,1,0] op_sel_hi:[0,1,1] neg_hi:[1,0,0]
    ds_write_addtid_b32 v121 offset:64352
    ds_write_addtid_b32 v126 offset:63776
    v_pk_mul_f16 v122, v120, v63 op_sel:[0,0] op_sel_hi:[1,0]
    v_pk_fma_f16 v122, v120, v63, v122 op_sel:[1,1,0] op_sel_hi:[0,1,1] neg_hi:[1,0,0]
    ds_write_addtid_b32 v122 offset:64928
    s_waitcnt vmcnt(2)
    v_perm_b32 v44, v20, v18, s82
    v_perm_b32 v45, v20, v18, s83
    v_perm_b32 v46, v21, v19, s82
    v_perm_b32 v47, v21, v19, s83
    ds_write_b32 v220, v44 offset:0
    ds_write_b32 v220, v45 offset:4864
    ds_write_b32 v220, v46 offset:9728
    ds_write_b32 v220, v47 offset:14592
    s_waitcnt lgkmcnt(0)
    s_barrier
    global_load_dwordx2 v[26:27], v221, s[8:9] offset:-2048
    global_load_dwordx2 v[28:29], v221, s[8:9] offset:2048
    s_mul_i32 s80, s80, 0x9e3779b1
    s_add_u32 s80, s80, 0x7f4a7c15
    s_or_b32 s80, s80, 1
    s_setprio 1
    s_waitcnt vmcnt(2)
    v_perm_b32 v48, v24, v22, s82
    v_perm_b32 v49, v24, v22, s83
    v_perm_b32 v50, v25, v23, s82
    v_perm_b32 v51, v25, v23, s83
    ds_write_b32 v220, v48 offset:256
    ds_write_b32 v220, v49 offset:5120
    ds_write_b32 v220, v50 offset:9984
    ds_write_b32 v220, v51 offset:14848
    ds_write_b8 v218, v228
    s_setprio 1
    s_cmp_eq_u32 s41, 0
    s_cbranch_scc1 L_kpa
    s_setprio 0
L_kpa:
    global_load_dwordx2 v[128:129], v208, s[38:39] offset:-4096 sc1
    global_load_dwordx2 v[130:131], v208, s[38:39] offset:-2048 sc1
    global_load_dwordx2 v[132:133], v208, s[38:39] offset:0 sc1
    global_load_dwordx2 v[134:135], v208, s[38:39] offset:2048 sc1
    global_load_dwordx2 v[30:31], v222, s[8:9] offset:-2048
    global_load_dwordx2 v[32:33], v222, s[8:9] offset:2048
    v_lshlrev_b32 v64, 16, v18
    v_and_b32 v65, 0xffff0000, v18
    v_lshlrev_b32 v66, 16, v19
    v_and_b32 v67, 0xffff0000, v19
    v_lshlrev_b32 v68, 16, v20
    v_and_b32 v69, 0xffff0000, v20
    v_lshlrev_b32 v70, 16, v21
    v_and_b32 v71, 0xffff0000, v21
    v_lshlrev_b32 v72, 16, v22
    v_and_b32 v73, 0xffff0000, v22
    v_lshlrev_b32 v74, 16, v23
    v_and_b32 v75, 0xffff0000, v23
    v_lshlrev_b32 v76, 16, v24
    v_and_b32 v77, 0xffff0000, v24
    v_lshlrev_b32 v78, 16, v25
    v_and_b32 v79, 0xffff0000, v25
    s_cmp_eq_u32 0, 0
    s_branch L_hop
L_hop_back:
    s_waitcnt vmcnt(6)
    v_perm_b32 v44, v28, v26, s82
    v_perm_b32 v45, v28, v26, s83
    v_perm_b32 v46, v29, v27, s82
    v_perm_b32 v47, v29, v27, s83
    ds_write_b32 v220, v44 offset:512
    ds_write_b32 v220, v45 offset:5376
    ds_write_b32 v220, v46 offset:10240
    ds_write_b32 v220, v47 offset:15104
    ds_write_b8 v218, v228 offset:4
    s_mov_b32 s58, 0
    s_waitcnt vmcnt(2)
    s_branch L_h_gc
L_h_g:
    s_cmp_lg_u32 s58, 1
    s_cbranch_scc1 L_h_g2
    s_waitcnt vmcnt(0)
    v_perm_b32 v48, v32, v30, s82
    v_perm_b32 v49, v32, v30, s83
    v_perm_b32 v50, v33, v31, s82
    v_perm_b32 v51, v33, v31, s83
    ds_write_b32 v220, v48 offset:768
    ds_write_b32 v220, v49 offset:5632
    ds_write_b32 v220, v50 offset:10496
    ds_write_b32 v220, v51 offset:15360
    ds_write_b8 v218, v228 offset:8
L_h_g2:
    s_sleep 2
    v_mov_b32 v13, 0
    global_load_dword v34, v13, s[36:37] sc1
    global_load_dwordx2 v[128:129], v208, s[38:39] offset:-4096 sc1
    global_load_dwordx2 v[130:131], v208, s[38:39] offset:-2048 sc1
    global_load_dwordx2 v[132:133], v208, s[38:39] offset:0 sc1
    global_load_dwordx2 v[134:135], v208, s[38:39] offset:2048 sc1
    s_waitcnt vmcnt(0)
    v_readfirstlane_b32 s81, v34
    s_cmp_lg_u32 s81, 0
    s_cselect_b32 s80, s81, s80
L_h_gc:
    s_add_u32 s58, s58, 1
    v_min3_u32 v16, v129, v131, v133
    v_max3_u32 v17, v129, v131, v133
    v_min3_u32 v16, v16, v135, s80
    v_max3_u32 v17, v17, v135, s80
    v_cmp_ne_u32 vcc, v16, v17
    s_cmp_gt_u32 s58, 1048576
    s_cbranch_scc1 L_h_gx
    s_cbranch_vccnz L_h_g
L_h_gx:
    s_mov_b32 s51, s58
    v_and_b32 v129, 0xffff0000, v128
    v_lshlrev_b32 v128, 16, v128
    s_mov_b32 s58, 0
    s_branch L_flag0
L_flags0:
    s_sleep 2
L_flag0:
    ds_read_b32 v16, v217 offset:0
    s_add_u32 s58, s58, 1
    s_cmp_gt_u32 s58, 1048576
    s_waitcnt lgkmcnt(0)
    v_readfirstlane_b32 s46, v16
    s_cbranch_scc1 L_flagx0
    s_cmp_lg_u32 s46, 16843009
    s_cbranch_scc1 L_flags0
L_flagx0:
    s_setprio 1
    ds_read_b128 v[144:147], v210 offset:0
    ds_read_b128 v[148:151], v216 offset:0
    ds_read_b128 v[152:155], v210 offset:256
    ds_read_b128 v[156:159], v214 offset:0
    s_waitcnt lgkmcnt(2)
    v_fmac_f32 v64, v128, v144
    v_fmac_f32 v65, v128, v145
    v_fmac_f32 v66, v128, v146
    v_fmac_f32 v67, v128, v147
    v_fmac_f32 v64, v128, v150
    v_fmac_f32 v65, v128, v151
    v_fmac_f32 v66, v128, v148
    v_fmac_f32 v67, v128, v149
    v_cvt_pk_bf16_f32 v112, v64, v65
    v_cvt_pk_bf16_f32 v113, v66, v67
    global_store_dwordx2 v209, v[112:113], s[56:57] offset:-2048
    s_waitcnt lgkmcnt(0)
    v_fmac_f32 v68, v129, v152
    v_fmac_f32 v69, v129, v153
    v_fmac_f32 v70, v129, v154
    v_fmac_f32 v71, v129, v155
    v_fmac_f32 v68, v129, v158
    v_fmac_f32 v69, v129, v159
    v_fmac_f32 v70, v129, v156
    v_fmac_f32 v71, v129, v157
    v_cvt_pk_bf16_f32 v114, v68, v69
    v_cvt_pk_bf16_f32 v115, v70, v71
    global_store_dwordx2 v209, v[114:115], s[56:57] offset:2048
    s_cmp_eq_u32 s41, 0
    s_cbranch_scc1 L_kp0
    s_setprio 0
L_kp0:
    s_add_u32 s56, s56, 0x80000
    s_addc_u32 s57, s57, 0
    s_cmp_lg_u32 s51, 1
    s_cbranch_scc1 L_h_t3
    s_waitcnt vmcnt(2)
    v_perm_b32 v48, v32, v30, s82
    v_perm_b32 v49, v32, v30, s83
    v_perm_b32 v50, v33, v31, s82
    v_perm_b32 v51, v33, v31, s83
    ds_write_b32 v220, v48 offset:768
    ds_write_b32 v220, v49 offset:5632
    ds_write_b32 v220, v50 offset:10496
    ds_write_b32 v220, v51 offset:15360
    ds_write_b8 v218, v228 offset:8
L_h_t3:
    v_and_b32 v131, 0xffff0000, v130
    v_lshlrev_b32 v130, 16, v130
    s_mov_b32 s58, 0
    s_branch L_flag1
L_flags1:
    s_sleep 2
L_flag1:
    ds_read_b32 v16, v217 offset:16
    s_add_u32 s58, s58, 1
    s_cmp_gt_u32 s58, 1048576
    s_waitcnt lgkmcnt(0)
    v_readfirstlane_b32 s46, v16
    s_cbranch_scc1 L_flagx1
    s_cmp_lg_u32 s46, 16843009
    s_cbranch_scc1 L_flags1
L_flagx1:
    ds_read_b128 v[144:147], v210 offset:17152
    ds_read_b128 v[148:151], v213 offset:0
    ds_read_b128 v[152:155], v210 offset:17408
    ds_read_b128 v[156:159], v214 offset:17152
    s_waitcnt lgkmcnt(2)
    v_fmac_f32 v72, v130, v144
    v_fmac_f32 v73, v130, v145
    v_fmac_f32 v74, v130, v146
    v_fmac_f32 v75, v130, v147
    v_fmac_f32 v72, v130, v150
    v_fmac_f32 v73, v130, v151
    v_fmac_f32 v74, v130, v148
    v_fmac_f32 v75, v130, v149
    v_cvt_pk_bf16_f32 v112, v72, v73
    v_cvt_pk_bf16_f32 v113, v74, v75
    global_store_dwordx2 v209, v[112:113], s[56:57] offset:-2048
    s_waitcnt lgkmcnt(0)
    s_load_dword s52, s[36:37], 132
    v_fmac_f32 v76, v131, v152
    v_fmac_f32 v77, v131, v153
    v_fmac_f32 v78, v131, v154
    v_fmac_f32 v79, v131, v155
    v_fmac_f32 v76, v131, v158
    v_fmac_f32 v77, v131, v159
    v_fmac_f32 v78, v131, v156
    v_fmac_f32 v79, v131, v157
    v_cvt_pk_bf16_f32 v114, v76, v77
    v_cvt_pk_bf16_f32 v115, v78, v79
    global_store_dwordx2 v209, v[114:115], s[56:57] offset:2048
    s_add_u32 s56, s56, 0x80000
    s_addc_u32 s57, s57, 0
    v_lshlrev_b32 v80, 16, v26
    v_and_b32 v81, 0xffff0000, v26
    v_lshlrev_b32 v82, 16, v27
    v_and_b32 v83, 0xffff0000, v27
    v_lshlrev_b32 v84, 16, v28
    v_and_b32 v85, 0xffff0000, v28
    v_lshlrev_b32 v86, 16, v29
    v_and_b32 v87, 0xffff0000, v29
    v_and_b32 v133, 0xffff0000, v132
    v_lshlrev_b32 v132, 16, v132
    v_lshlrev_b32 v88, 16, v30
    v_and_b32 v89, 0xffff0000, v30
    v_lshlrev_b32 v90, 16, v31
    v_and_b32 v91, 0xffff0000, v31
    v_lshlrev_b32 v92, 16, v32
    v_and_b32 v93, 0xffff0000, v32
    v_lshlrev_b32 v94, 16, v33
    v_and_b32 v95, 0xffff0000, v33
    v_and_b32 v135, 0xffff0000, v134
    v_lshlrev_b32 v134, 16, v134
    s_waitcnt lgkmcnt(0)
    s_cmp_lg_u32 s52, 0
    s_cbranch_scc1 L_h_key
    v_lshlrev_b32 v13, 7, v9
    v_add_u32 v13, 16384, v13
    s_mov_b32 s58, 0
L_h_pk:
    s_sleep 1
    global_load_dwordx2 v[14:15], v13, s[38:39] sc1
    s_add_u32 s58, s58, 1
    s_waitcnt vmcnt(0)
    v_cmp_ne_u32 vcc, s80, v15
    s_cmp_gt_u32 s58, 1048576
    s_cbranch_scc1 L_h_pk_x
    s_cbranch_vccnz L_h_pk
L_h_pk_x:
    s_nop 1
    v_max_u32_dpp v14, v14, v14 row_shr:1 row_mask:0xf bank_mask:0xf
    s_nop 1
    v_max_u32_dpp v14, v14, v14 row_shr:2 row_mask:0xf bank_mask:0xf
    s_nop 1
    v_max_u32_dpp v14, v14, v14 row_shr:4 row_mask:0xf bank_mask:0xf
    s_nop 1
    v_max_u32_dpp v14, v14, v14 row_shr:8 row_mask:0xf bank_mask:0xf
    s_nop 1
    v_max_u32_dpp v14, v14, v14 row_bcast:15 row_mask:0xa bank_mask:0xf
    s_nop 1
    v_max_u32_dpp v14, v14, v14 row_bcast:31 row_mask:0xc bank_mask:0xf
    s_nop 0
    v_readlane_b32 s52, v14, 63
L_h_key:
    s_not_b32 s53, s52
    s_bfe_u32 s46, s53, 0x20007
    s_bfe_u32 s54, s53, 0x20009
    s_bfe_u32 s47, s53, 0x10002
    s_lshl1_add_u32 s54, s54, s47
    s_cmp_eq_u32 s46, s44
    s_cselect_b32 s54, s54, 8
    s_bfe_u32 s46, s53, 0x40003
    s_and_b32 s47, s53, 3
    s_lshl2_add_u32 s55, s46, s47
    s_lshl_b64 s[48:49], 1, s55
    s_mov_b32 s58, 0
    s_branch L_flag2
L_flags2:
    s_sleep 2
L_flag2:
    ds_read_b32 v16, v217 offset:32
    s_add_u32 s58, s58, 1
    s_cmp_gt_u32 s58, 1048576
    s_waitcnt lgkmcnt(0)
    v_readfirstlane_b32 s46, v16
    s_cbranch_scc1 L_flagx2
    s_cmp_lg_u32 s46, 16843009
    s_cbranch_scc1 L_flags2
L_flagx2:
    ds_read_b128 v[144:147], v210 offset:34304
    ds_read_b128 v[148:151], v213 offset:17152
    ds_read_b128 v[152:155], v210 offset:34560
    ds_read_b128 v[156:159], v214 offset:34304
    s_cmp_eq_u32 s54, 4
    s_cselect_b64 s[46:47], s[48:49], 0
    s_waitcnt lgkmcnt(2)
    v_fmac_f32 v80, v132, v144
    v_fmac_f32 v81, v132, v145
    v_fmac_f32 v82, v132, v146
    v_fmac_f32 v83, v132, v147
    v_fmac_f32 v80, v132, v150
    v_fmac_f32 v81, v132, v151
    v_fmac_f32 v82, v132, v148
    v_fmac_f32 v83, v132, v149
    v_cvt_pk_bf16_f32 v112, v80, v81
    v_cvt_pk_bf16_f32 v113, v82, v83
    s_not_b64 exec, s[46:47]
    global_store_dwordx2 v209, v[112:113], s[56:57] offset:-2048
    s_mov_b64 exec, -1
    s_cmp_eq_u32 s54, 5
    s_cselect_b64 s[46:47], s[48:49], 0
    s_waitcnt lgkmcnt(0)
    v_fmac_f32 v84, v133, v152
    v_fmac_f32 v85, v133, v153
    v_fmac_f32 v86, v133, v154
    v_fmac_f32 v87, v133, v155
    v_fmac_f32 v84, v133, v158
    v_fmac_f32 v85, v133, v159
    v_fmac_f32 v86, v133, v156
    v_fmac_f32 v87, v133, v157
    v_cvt_pk_bf16_f32 v114, v84, v85
    v_cvt_pk_bf16_f32 v115, v86, v87
    s_not_b64 exec, s[46:47]
    global_store_dwordx2 v209, v[114:115], s[56:57] offset:2048
    s_mov_b64 exec, -1
    s_add_u32 s56, s56, 0x80000
    s_addc_u32 s57, s57, 0
    s_mov_b32 s58, 0
    s_branch L_flag3
L_flags3:
    s_sleep 2
L_flag3:
    ds_read_b32 v16, v217 offset:44
    s_add_u32 s58, s58, 1
    s_cmp_gt_u32 s58, 1048576
    s_waitcnt lgkmcnt(0)
    v_readfirstlane_b32 s46, v16
    s_cbranch_scc1 L_flagx3
    s_cmp_lg_u32 s46, 16843009
    s_cbranch_scc1 L_flags3
L_flagx3:
    s_mov_b32 s58, 4290772992
L_tight:
    ds_read_b32 v16, v217 offset:48
    ds_read_b128 v[144:147], v210 offset:51456
    ds_read_b128 v[148:151], v213 offset:34304
    ds_read_b128 v[152:155], v210 offset:51712
    ds_read_b128 v[156:159], v214 offset:51456
    s_add_u32 s58, s58, 1
    s_cbranch_scc1 L_tightx
    s_waitcnt lgkmcnt(4)
    v_cmp_ne_u32 vcc, s84, v16
    s_cbranch_vccnz L_tight
L_tightx:
    s_setprio 1
    s_cmp_lg_u32 s44, 0
    s_cbranch_scc1 L_notry
    s_mov_b32 exec_hi, 0x00ffffff
    global_load_dword v224, v219, s[38:39] offset:-4096 sc1
    global_load_dword v225, v219, s[38:39] offset:-2048 sc1
    global_load_dword v226, v219, s[38:39] offset:0 sc1
    global_load_dword v227, v219, s[38:39] offset:2048 sc1
    s_mov_b32 exec_hi, -1
L_notry:
    s_cmp_eq_u32 s54, 6
    s_cselect_b64 s[46:47], s[48:49], 0
    s_waitcnt lgkmcnt(2)
    v_fmac_f32 v88, v134, v144
    v_fmac_f32 v89, v134, v145
    v_fmac_f32 v90, v134, v146
    v_fmac_f32 v91, v134, v147
    v_fmac_f32 v88, v134, v150
    v_fmac_f32 v89, v134, v151
    v_fmac_f32 v90, v134, v148
    v_fmac_f32 v91, v134, v149
    v_cvt_pk_bf16_f32 v112, v88, v89
    v_cvt_pk_bf16_f32 v113, v90, v91
    s_not_b64 exec, s[46:47]
    global_store_dwordx2 v209, v[112:113], s[56:57] offset:-2048
    s_mov_b64 exec, -1
    s_cmp_eq_u32 s54, 7
    s_cselect_b64 s[46:47], s[48:49], 0
    s_waitcnt lgkmcnt(0)
    v_fmac_f32 v92, v135, v152
    v_fmac_f32 v93, v135, v153
    v_fmac_f32 v94, v135, v154
    v_fmac_f32 v95, v135, v155
    v_fmac_f32 v92, v135, v158
    v_fmac_f32 v93, v135, v159
    v_fmac_f32 v94, v135, v156
    v_fmac_f32 v95, v135, v157
    v_cvt_pk_bf16_f32 v114, v92, v93
    v_cvt_pk_bf16_f32 v115, v94, v95
    s_not_b64 exec, s[46:47]
    global_store_dwordx2 v209, v[114:115], s[56:57] offset:2048
    s_mov_b64 exec, -1
    s_cmp_lg_u32 s44, 0
    s_cbranch_scc1 L_own
    s_mov_b32 s58, 0
    s_waitcnt vmcnt(2)
    s_branch L_ypc
L_yps:
    s_sleep 0
L_yp:
    s_mov_b32 exec_hi, 0x00ffffff
    global_load_dword v224, v219, s[38:39] offset:-4096 sc1
    global_load_dword v225, v219, s[38:39] offset:-2048 sc1
    global_load_dword v226, v219, s[38:39] offset:0 sc1
    global_load_dword v227, v219, s[38:39] offset:2048 sc1
    s_mov_b32 exec_hi, -1
    s_add_u32 s58, s58, 1
    s_waitcnt vmcnt(0)
L_ypc:
    s_mov_b32 exec_hi, 0x00ffffff
    v_min3_u32 v16, v224, v225, v226
    v_min_u32 v16, v16, v227
    v_cmp_eq_u32 vcc, 0, v16
    s_mov_b32 exec_hi, -1
    s_cmp_gt_u32 s58, 1048576
    s_cbranch_scc1 L_ypx
    s_cbranch_vccnz L_yps
L_ypx:
    s_setprio 1
    v_add_f32 v16, v224, v225
    v_add_f32 v17, v226, v227
    v_add_f32 v16, v16, v17
    s_nop 1
    v_add_f32_dpp v16, v16, v16 row_ror:8 row_mask:0xf bank_mask:0xf
    s_nop 1
    v_add_f32_dpp v16, v16, v16 row_ror:4 row_mask:0xf bank_mask:0xf
    v_mov_b32 v17, v16
    s_nop 1
    v_permlane16_swap_b32 v16, v17
    v_add_f32 v16, v16, v17
    v_mov_b32 v17, v16
    s_nop 1
    v_permlane32_swap_b32 v16, v17
    v_add_f32 v16, v16, v17
    v_or_b32 v16, 1, v16
    ds_write_b32 v230, v16
L_own:
    s_cmp_eq_u32 s54, 8
    s_cbranch_scc1 L_done
    s_lshl_b32 s46, s54, 2
    s_set_gpr_idx_on s54, gpr_idx(SRC0)
    s_nop 0
    v_mov_b32 v33, v128
    s_set_gpr_idx_idx s46
    s_nop 0
    v_mov_b32 v96, v64
    v_mov_b32 v97, v65
    v_mov_b32 v98, v66
    v_mov_b32 v99, v67
    s_set_gpr_idx_off
    v_sub_f32 v33, 1.0, v33
    s_and_b32 s46, s53, 0x7ff
    s_lshl_b32 s46, s46, 10
    s_add_u32 s46, s46, s45
    v_mov_b32 v6, s46
    s_mov_b32 s58, 0
    s_waitcnt vmcnt(4)
L_yw:
    ds_read_b128 v[36:39], v229
    s_add_u32 s58, s58, 1
    s_waitcnt lgkmcnt(0)
    v_min3_u32 v16, v36, v37, v38
    v_min_u32 v16, v16, v39
    v_cmp_eq_u32 vcc, 0, v16
    s_cmp_gt_u32 s58, 8388608
    s_cbranch_scc1 L_fin
    s_cbranch_vccnz L_yw
L_fin:
    v_fmac_f32 v96, v36, v33
    v_fmac_f32 v97, v37, v33
    v_fmac_f32 v98, v38, v33
    v_fmac_f32 v99, v39, v33
    v_cvt_pk_bf16_f32 v116, v96, v97
    v_cvt_pk_bf16_f32 v117, v98, v99
    s_mov_b64 exec, s[48:49]
    global_store_dwordx2 v6, v[116:117], s[34:35]
L_done:
    s_endpgm
L_root:
    s_lshl3_add_u32 s44, s2, s40
    s_cmp_lg_u32 s44, 516
    s_cbranch_scc1 L_exit
    v_lshlrev_b32 v5, 7, v9
    v_add_u32 v3, 16384, v5
    s_waitcnt lgkmcnt(0)
    s_load_dword s80, s[38:39], 28672
    s_waitcnt lgkmcnt(0)
    s_add_u32 s44, s80, 1
    s_mul_i32 s80, s80, 0x9e3779b1
    s_add_u32 s80, s80, 0x7f4a7c15
    s_or_b32 s80, s80, 1
    s_mov_b32 s58, 0
L_root_pk:
    s_sleep 1
    global_load_dwordx2 v[6:7], v3, s[38:39] sc1
    s_add_u32 s58, s58, 1
    s_waitcnt vmcnt(0)
    v_cmp_ne_u32 vcc, s80, v7
    s_cmp_gt_u32 s58, 1048576
    s_cbranch_scc1 L_root_pk_x
    s_cbranch_vccnz L_root_pk
L_root_pk_x:
    s_nop 1
    v_max_u32_dpp v6, v6, v6 row_shr:1 row_mask:0xf bank_mask:0xf
    s_nop 1
    v_max_u32_dpp v6, v6, v6 row_shr:2 row_mask:0xf bank_mask:0xf
    s_nop 1
    v_max_u32_dpp v6, v6, v6 row_shr:4 row_mask:0xf bank_mask:0xf
    s_nop 1
    v_max_u32_dpp v6, v6, v6 row_shr:8 row_mask:0xf bank_mask:0xf
    s_nop 1
    v_max_u32_dpp v6, v6, v6 row_bcast:15 row_mask:0xa bank_mask:0xf
    s_nop 1
    v_max_u32_dpp v6, v6, v6 row_bcast:31 row_mask:0xc bank_mask:0xf
    s_nop 0
    v_readlane_b32 s52, v6, 63
    s_mov_b64 exec, 3
    v_mov_b32 v6, s80
    v_mov_b32 v7, s52
    global_store_dwordx2 v5, v[6:7], s[36:37] sc1
    v_mov_b32 v3, 28672
    v_mov_b32 v4, s44
    s_mov_b64 exec, 1
    s_waitcnt vmcnt(0)
    global_store_dword v3, v4, s[38:39] sc1
    s_branch L_done
L_exit:
    s_endpgm
L_code_end:
.section .rodata,"a"
.p2align 6
.amdhsa_kernel gated_mix__ssm_conv_s4d__moe_arch_mod__prompt_kernel
  .amdhsa_next_free_vgpr 256
  .amdhsa_next_free_sgpr 100
  .amdhsa_accum_offset 256
  .amdhsa_group_segment_fixed_size 0
  .amdhsa_kernarg_size 128
  .amdhsa_user_sgpr_count 2
  .amdhsa_user_sgpr_kernarg_segment_ptr 1
  .amdhsa_system_sgpr_workgroup_id_x 1
.end_amdhsa_kernel
```
